```python
import torch

def _softmax(x, axis=-1):
    return torch.softmax(x, dim=axis)

def _gelu(x):
    return torch.nn.functional.gelu(x, approximate='tanh')

def _silu(x):
    return torch.nn.functional.silu(x)

def _sigmoid(x):
    return torch.sigmoid(x)

def _layernorm(x, axis=-1, eps=1e-05):
    m = x.mean(dim=axis, keepdim=True)
    v = x.var(dim=axis, keepdim=True, unbiased=False)
    return (x - m) / torch.sqrt(v + eps)

def _scatter_add(tgt, idx, src, axis=0):
    return tgt.clone().index_add_(axis, idx, src)

def _segment_sum(src, seg, n):
    out = torch.zeros((n,) + src.shape[1:], dtype=src.dtype)
    return out.index_add_(0, seg, src)

def _pad(x, pw):
    flat = tuple((v for pair in reversed(pw) for v in pair))
    return torch.nn.functional.pad(x, flat)
kernel_name = 'standalone__detection_seg_detr_decoder__vision'

def setup_inputs():

    _w = lambda a: (lambda t: t.to(torch.bfloat16) if t.is_floating_point() else t)(torch.as_tensor(a))
    H = W = 384 // 2 * 2
    C = 384
    Nq = 32
    return {'q': _w((lambda *s: torch.randn(*s, dtype=torch.bfloat16) * 0.05)(1, Nq, C)), 'feat_hi': _w((lambda *s: torch.randn(*s, dtype=torch.bfloat16) * 0.1)(1, H, W, C)), 'feat_lo': _w((lambda *s: torch.randn(*s, dtype=torch.bfloat16) * 0.1)(1, H // 2, W // 2, C)), 'lat_hi': _w((lambda *s: torch.randn(*s, dtype=torch.bfloat16) * 0.1)(C, C)), 'lat_lo': _w((lambda *s: torch.randn(*s, dtype=torch.bfloat16) * 0.1)(C, C)), 'wq': _w((lambda *s: torch.randn(*s, dtype=torch.bfloat16) * 0.1)(C, C)), 'wkv': _w((lambda *s: torch.randn(*s, dtype=torch.bfloat16) * 0.1)(C, 2 * C)), 'wo': _w((lambda *s: torch.randn(*s, dtype=torch.bfloat16) * 0.05)(C, C)), 'w1': _w((lambda *s: torch.randn(*s, dtype=torch.bfloat16) * 0.05)(C, 4 * C)), 'w2': _w((lambda *s: torch.randn(*s, dtype=torch.bfloat16) * 0.05)(4 * C, C))}

def reference(q, feat_hi, feat_lo, lat_hi, lat_lo, wq, wkv, wo, w1, w2):
    B, Nq, C = q.shape
    _, H, W, _ = feat_hi.shape
    lo = feat_lo @ lat_lo
    up = (lambda x, n, axis: torch.repeat_interleave(x, n, dim=axis))((lambda x, n, axis: torch.repeat_interleave(x, n, dim=axis))(lo, 2, axis=1), 2, axis=2)
    fused = feat_hi @ lat_hi + up
    mem = fused.reshape(B, H * W, C)
    qn = _layernorm(q, axis=-1)
    Q = qn @ wq
    KV = mem @ wkv
    K, V = (KV[..., :C].clone(), KV[..., C:].clone())
    scale = C ** (-0.5)
    logits = torch.einsum('bqc,bkc->bqk', Q, K) * scale
    P = _softmax(logits, axis=-1)
    O = torch.einsum('bqk,bkc->bqc', P, V)
    h = q + O @ wo
    hn = _layernorm(h, axis=-1)
    return h + _gelu(hn @ w1) @ w2
```

```asm
; @launch grid=(256,1,1) block=(512,1,1) lds=163840
.amdgcn_target "amdgcn-amd-amdhsa--gfx950"
.text
.globl standalone__detection_seg_detr_decoder__vision_kernel
.p2align 8
.type standalone__detection_seg_detr_decoder__vision_kernel,@function
standalone__detection_seg_detr_decoder__vision_kernel:
K_entry:
s_load_dwordx4 s[52:55], s[0:1], 88
s_load_dwordx8 s[56:63], s[0:1], 0
v_lshrrev_b32 v1, 6, v0
v_and_b32 v3, 63, v0
s_cmp_ge_u32 s2, 256
s_cbranch_scc1 K_done
v_readfirstlane_b32 s3, v1
s_lshr_b32 s17, s2, 3
s_lshl_b32 s6, s3, 5
s_add_u32 s6, s6, s17
s_sub_u32 s16, s6, 187
s_cmp_lt_u32 s16, 5
s_cbranch_scc0 K_nct
s_getpc_b64 s[6:7]
K_pc:
s_lshl_b32 s16, s16, 13
v_lshl_add_u32 v4, v3, 7, s16
v_min_u32 v4, K_done-K_pc, v4
global_load_dword v255, v4, s[6:7]
K_nct:
s_bfe_u32 s16, s2, 0x10002
s_add_u32 s18, s2, 1
s_and_b32 s18, s18, 3
s_cbranch_scc1 K_streamer
s_load_dwordx16 s[36:51], s[0:1], 24
s_mov_b32 s86, s16
s_mov_b32 s87, s17
s_lshl_b32 s2, s16, 5
s_add_u32 s2, s2, s17
s_mov_b32 s101, 0
v_and_b32 v1, 15, v0
v_bfe_u32 v2, v0, 4, 2
v_lshlrev_b32 v8, 4, v3
v_lshrrev_b32 v4, 2, v3
v_mul_u32_u24 v10, 768, v4
v_and_b32 v4, 3, v3
v_lshl_add_u32 v10, v4, 4, v10
v_mov_b32 v20, -1
v_mov_b32 v21, -1
v_mov_b32 v22, -1
v_mov_b32 v23, -1
s_waitcnt lgkmcnt(0)
s_mov_b32 s32, s54
s_and_b32 s33, s55, 0xffff
s_mov_b32 s34, 452984832
s_mov_b32 s35, 0x20000
s_mov_b32 s8, s56
s_and_b32 s9, s57, 0xffff
s_mov_b32 s10, 24576
s_mov_b32 s11, 0x20000
s_mov_b32 s88, s52
s_and_b32 s89, s53, 0xffff
s_mov_b32 s90, 256
s_mov_b32 s91, 0x20000
s_cmp_ge_u32 s87, 14
s_cbranch_scc1 H_bc
s_cmp_ge_u32 s87, 2
s_cbranch_scc1 H_a
s_lshl_b32 s12, s86, 1
s_add_u32 s12, s12, s87
s_mul_i32 s6, s12, 24576
s_mul_i32 s7, s3, 3072
s_add_u32 s13, s6, s7
buffer_store_dwordx4 v[20:23], v8, s[32:35], s13 offen offset:0 sc1
buffer_store_dwordx4 v[20:23], v8, s[32:35], s13 offen offset:1024 sc1
buffer_store_dwordx4 v[20:23], v8, s[32:35], s13 offen offset:2048 sc1
s_lshl_b32 s14, s86, 7
s_mov_b32 s15, 1
s_cmp_eq_u32 s87, 0
s_cbranch_scc0 RF_1
s_waitcnt vmcnt(0)
s_barrier
s_cmp_lg_u32 s3, 0
s_cbranch_scc1 RF_0
s_atomic_add s15, s[52:53], s14
RF_0:
buffer_load_dwordx4 v[24:27], v8, s[32:35], s13 offen offset:0 sc1
buffer_load_dwordx4 v[28:31], v8, s[32:35], s13 offen offset:1024 sc1
buffer_load_dwordx4 v[32:35], v8, s[32:35], s13 offen offset:2048 sc1
s_branch H_roles_done
RF_1:
v_lshrrev_b32 v4, 3, v3
v_lshlrev_b32 v4, 10, v4
v_and_b32 v5, 7, v3
v_lshl_add_u32 v4, v5, 4, v4
s_lshl_b32 s6, s86, 14
s_lshl_b32 s7, s3, 13
s_add_u32 s6, s6, s7
s_add_u32 s6, s6, 98304
s_cmp_ge_u32 s3, 2
s_cbranch_scc1 RF_2
buffer_store_dwordx4 v[20:23], v4, s[32:35], s6 offen sc1
RF_2:
s_waitcnt vmcnt(0)
s_barrier
s_cmp_lg_u32 s3, 0
s_cbranch_scc1 H_roles_done
s_lshl_b32 s24, s86, 7
s_mov_b32 s30, 2097152
W1:
buffer_load_dwordx2 v[44:45], off, s[88:91], s24 sc1
s_sub_u32 s30, s30, 1
s_cselect_b32 s25, 0, 1
s_waitcnt vmcnt(0)
v_cmp_gt_u32 vcc, s25, v44
s_cbranch_vccnz W1
s_add_u32 s14, s14, 4
s_atomic_add s15, s[52:53], s14
s_branch H_roles_done
H_a:
s_mov_b32 s12, s86
s_sub_u32 s13, s87, 2
s_lshl_b32 s14, s13, 10
s_mul_i32 s6, s12, 49152
s_add_u32 s14, s14, s6
s_lshl_b32 s15, s13, 6
v_lshrrev_b32 v4, 5, v3
v_and_b32 v5, 31, v3
v_mul_u32_u24 v6, 768, v4
v_lshl_add_u32 v6, v5, 3, v6
s_lshl_b32 s16, s13, 2
s_add_u32 s16, s16, s3
s_and_b32 s16, s16, 7
s_lshl_b32 s6, s12, 3
s_add_u32 s6, s6, s16
s_mul_i32 s6, s6, 1536
buffer_load_dwordx2 v[24:25], v6, s[8:11], s6 offen offset:0
buffer_load_dwordx2 v[26:27], v6, s[8:11], s6 offen offset:256
buffer_load_dwordx2 v[28:29], v6, s[8:11], s6 offen offset:512
s_mov_b32 s92, s40
s_and_b32 s93, s41, 0xffff
s_mov_b32 s94, 294912
s_mov_b32 s95, 0x20000
s_mul_i32 s6, s16, 36864
s_add_u32 s6, s6, s15
s_mul_i32 s7, s16, 3072
s_add_u32 m0, s7, 0
s_nop 0
buffer_load_dwordx4 v10, s[92:95], s6 offen lds
s_add_u32 s6, s6, 12288
s_add_u32 m0, s7, 1024
s_nop 0
buffer_load_dwordx4 v10, s[92:95], s6 offen lds
s_add_u32 s6, s6, 12288
s_add_u32 m0, s7, 2048
s_nop 0
buffer_load_dwordx4 v10, s[92:95], s6 offen lds
v_mul_u32_u24 v7, 800, v4
v_lshl_add_u32 v7, v5, 3, v7
s_mul_i32 s6, s16, 1600
s_add_u32 s6, s6, 24576
v_add_u32 v7, s6, v7
s_waitcnt vmcnt(3)
v_lshlrev_b32 v32, 16, v24
v_and_b32 v33, 0xffff0000, v24
v_lshlrev_b32 v34, 16, v25
v_and_b32 v35, 0xffff0000, v25
v_lshlrev_b32 v36, 16, v26
v_and_b32 v37, 0xffff0000, v26
v_lshlrev_b32 v38, 16, v27
v_and_b32 v39, 0xffff0000, v27
v_lshlrev_b32 v40, 16, v28
v_and_b32 v41, 0xffff0000, v28
v_lshlrev_b32 v42, 16, v29
v_and_b32 v43, 0xffff0000, v29
v_add_f32 v4, v32, v33
v_add_f32 v4, v4, v34
v_add_f32 v4, v4, v35
v_add_f32 v4, v4, v36
v_add_f32 v4, v4, v37
v_add_f32 v4, v4, v38
v_add_f32 v4, v4, v39
v_add_f32 v4, v4, v40
v_add_f32 v4, v4, v41
v_add_f32 v4, v4, v42
v_add_f32 v4, v4, v43
s_nop 1
v_add_f32_dpp v4, v4, v4 row_ror:8 row_mask:0xf bank_mask:0xf
s_nop 1
v_add_f32_dpp v4, v4, v4 row_ror:4 row_mask:0xf bank_mask:0xf
s_nop 1
v_add_f32_dpp v4, v4, v4 row_ror:2 row_mask:0xf bank_mask:0xf
s_nop 1
v_add_f32_dpp v4, v4, v4 row_ror:1 row_mask:0xf bank_mask:0xf
v_mov_b32 v5, v4
s_nop 1
v_permlane16_swap_b32 v5, v4
s_nop 0
v_add_f32 v4, v4, v5
v_mul_f32 v4, 0x3b2aaaab, v4
v_sub_f32 v32, v32, v4
v_sub_f32 v33, v33, v4
v_sub_f32 v34, v34, v4
v_sub_f32 v35, v35, v4
v_sub_f32 v36, v36, v4
v_sub_f32 v37, v37, v4
v_sub_f32 v38, v38, v4
v_sub_f32 v39, v39, v4
v_sub_f32 v40, v40, v4
v_sub_f32 v41, v41, v4
v_sub_f32 v42, v42, v4
v_sub_f32 v43, v43, v4
v_mul_f32 v4, v32, v32
v_fmac_f32 v4, v33, v33
v_fmac_f32 v4, v34, v34
v_fmac_f32 v4, v35, v35
v_fmac_f32 v4, v36, v36
v_fmac_f32 v4, v37, v37
v_fmac_f32 v4, v38, v38
v_fmac_f32 v4, v39, v39
v_fmac_f32 v4, v40, v40
v_fmac_f32 v4, v41, v41
v_fmac_f32 v4, v42, v42
v_fmac_f32 v4, v43, v43
s_nop 1
v_add_f32_dpp v4, v4, v4 row_ror:8 row_mask:0xf bank_mask:0xf
s_nop 1
v_add_f32_dpp v4, v4, v4 row_ror:4 row_mask:0xf bank_mask:0xf
s_nop 1
v_add_f32_dpp v4, v4, v4 row_ror:2 row_mask:0xf bank_mask:0xf
s_nop 1
v_add_f32_dpp v4, v4, v4 row_ror:1 row_mask:0xf bank_mask:0xf
v_mov_b32 v5, v4
s_nop 1
v_permlane16_swap_b32 v5, v4
s_nop 0
v_add_f32 v4, v4, v5
v_mov_b32 v5, 0x3727c5ac
v_fmac_f32 v5, 0x3b2aaaab, v4
v_rsq_f32 v5, v5
s_nop 0
v_mul_f32 v32, v32, v5
v_mul_f32 v33, v33, v5
v_mul_f32 v34, v34, v5
v_mul_f32 v35, v35, v5
v_mul_f32 v36, v36, v5
v_mul_f32 v37, v37, v5
v_mul_f32 v38, v38, v5
v_mul_f32 v39, v39, v5
v_mul_f32 v40, v40, v5
v_mul_f32 v41, v41, v5
v_mul_f32 v42, v42, v5
v_mul_f32 v43, v43, v5
v_cvt_pk_bf16_f32 v24, v32, v33
v_cvt_pk_bf16_f32 v25, v34, v35
v_cvt_pk_bf16_f32 v26, v36, v37
v_cvt_pk_bf16_f32 v27, v38, v39
v_cvt_pk_bf16_f32 v28, v40, v41
v_cvt_pk_bf16_f32 v29, v42, v43
ds_write_b64 v7, v[24:25] offset:0
ds_write_b64 v7, v[26:27] offset:256
ds_write_b64 v7, v[28:29] offset:512
v_lshrrev_b32 v4, 2, v1
v_lshl_add_u32 v4, v2, 3, v4
v_lshlrev_b32 v4, 6, v4
v_and_b32 v5, 3, v1
v_lshl_add_u32 v4, v5, 4, v4
s_lshl_b32 s6, s3, 3
v_add_u32 v4, s6, v4
v_mul_u32_u24 v5, 800, v1
v_lshl_add_u32 v5, v2, 4, v5
v_add_u32 v5, 24576, v5
s_add_u32 s14, s14, s6
s_waitcnt vmcnt(0) lgkmcnt(0)
s_cmp_ge_u32 s3, 2
s_cbranch_scc1 A_nf
s_lshl_b32 s24, s86, 7
buffer_load_dword v44, off, s[88:91], s24 sc1
A_nf:
s_barrier
s_cmp_lt_u32 s3, 2
s_cbranch_scc1 A_mm
s_add_u32 s13, s13, 12
s_barrier
s_cmp_eq_u32 s3, 3
s_cbranch_scc1 BC_job
s_branch H_roles_done
A_mm:
ds_read_b64_tr_b16 v[64:65], v4 offset:0
ds_read_b64_tr_b16 v[66:67], v4 offset:256
ds_read_b128 v[112:115], v5 offset:0
ds_read_b64_tr_b16 v[68:69], v4 offset:2048
ds_read_b64_tr_b16 v[70:71], v4 offset:2304
ds_read_b128 v[116:119], v5 offset:64
ds_read_b64_tr_b16 v[72:73], v4 offset:4096
ds_read_b64_tr_b16 v[74:75], v4 offset:4352
ds_read_b128 v[120:123], v5 offset:128
ds_read_b64_tr_b16 v[76:77], v4 offset:6144
ds_read_b64_tr_b16 v[78:79], v4 offset:6400
ds_read_b128 v[124:127], v5 offset:192
s_waitcnt lgkmcnt(9)
v_mfma_f32_16x16x32_bf16 v[24:27], v[64:67], v[112:115], 0
ds_read_b64_tr_b16 v[80:81], v4 offset:8192
ds_read_b64_tr_b16 v[82:83], v4 offset:8448
ds_read_b128 v[128:131], v5 offset:256
s_waitcnt lgkmcnt(9)
v_mfma_f32_16x16x32_bf16 v[24:27], v[68:71], v[116:119], v[24:27]
ds_read_b64_tr_b16 v[84:85], v4 offset:10240
ds_read_b64_tr_b16 v[86:87], v4 offset:10496
ds_read_b128 v[132:135], v5 offset:320
s_waitcnt lgkmcnt(9)
v_mfma_f32_16x16x32_bf16 v[24:27], v[72:75], v[120:123], v[24:27]
ds_read_b64_tr_b16 v[88:89], v4 offset:12288
ds_read_b64_tr_b16 v[90:91], v4 offset:12544
ds_read_b128 v[136:139], v5 offset:384
s_waitcnt lgkmcnt(9)
v_mfma_f32_16x16x32_bf16 v[24:27], v[76:79], v[124:127], v[24:27]
ds_read_b64_tr_b16 v[92:93], v4 offset:14336
ds_read_b64_tr_b16 v[94:95], v4 offset:14592
ds_read_b128 v[140:143], v5 offset:448
s_waitcnt lgkmcnt(9)
v_mfma_f32_16x16x32_bf16 v[24:27], v[80:83], v[128:131], v[24:27]
ds_read_b64_tr_b16 v[96:97], v4 offset:16384
ds_read_b64_tr_b16 v[98:99], v4 offset:16640
ds_read_b128 v[144:147], v5 offset:512
s_waitcnt lgkmcnt(9)
v_mfma_f32_16x16x32_bf16 v[24:27], v[84:87], v[132:135], v[24:27]
ds_read_b64_tr_b16 v[100:101], v4 offset:18432
ds_read_b64_tr_b16 v[102:103], v4 offset:18688
ds_read_b128 v[148:151], v5 offset:576
s_waitcnt lgkmcnt(9)
v_mfma_f32_16x16x32_bf16 v[24:27], v[88:91], v[136:139], v[24:27]
ds_read_b64_tr_b16 v[104:105], v4 offset:20480
ds_read_b64_tr_b16 v[106:107], v4 offset:20736
ds_read_b128 v[152:155], v5 offset:640
s_waitcnt lgkmcnt(9)
v_mfma_f32_16x16x32_bf16 v[24:27], v[92:95], v[140:143], v[24:27]
ds_read_b64_tr_b16 v[108:109], v4 offset:22528
ds_read_b64_tr_b16 v[110:111], v4 offset:22784
ds_read_b128 v[156:159], v5 offset:704
s_waitcnt lgkmcnt(9)
v_mfma_f32_16x16x32_bf16 v[24:27], v[96:99], v[144:147], v[24:27]
s_waitcnt lgkmcnt(6)
v_mfma_f32_16x16x32_bf16 v[24:27], v[100:103], v[148:151], v[24:27]
s_waitcnt lgkmcnt(3)
v_mfma_f32_16x16x32_bf16 v[24:27], v[104:107], v[152:155], v[24:27]
s_waitcnt lgkmcnt(0)
v_mfma_f32_16x16x32_bf16 v[24:27], v[108:111], v[156:159], v[24:27]
s_waitcnt vmcnt(0)
v_cmp_eq_u32 vcc, 0, v44
s_nop 4
s_cbranch_vccz A_st
s_lshl_b32 s24, s86, 7
s_mov_b32 s30, 2097152
W2:
buffer_load_dwordx2 v[44:45], off, s[88:91], s24 sc1
s_sub_u32 s30, s30, 1
s_cselect_b32 s25, 0, 1
s_waitcnt vmcnt(0)
v_cmp_gt_u32 vcc, s25, v44
s_cbranch_vccnz W2
A_st:
v_cvt_pk_bf16_f32 v40, v24, v25
v_cvt_pk_bf16_f32 v41, v26, v27
buffer_store_dwordx2 v[40:41], v8, s[32:35], s14 offen
s_barrier
v_min_u32 v44, 11, v3
v_lshlrev_b32 v44, 10, v44
s_mul_i32 s24, s86, 49152
s_add_u32 s24, s24, 12288
s_mov_b32 s30, 24
W3:
buffer_load_dword v45, v44, s[32:35], s24 offen sc1
s_waitcnt vmcnt(0)
v_cmp_eq_u32 vcc, -1, v45
s_cbranch_vccz H_roles_done
s_sleep 4
s_sub_u32 s30, s30, 1
s_cbranch_scc0 W3
buffer_store_dwordx2 v[40:41], v8, s[32:35], s14 offen sc1
s_branch H_roles_done
H_bc:
s_sub_u32 s6, s3, 2
s_cmp_ge_u32 s6, 2
s_cbranch_scc1 H_roles_done
s_sub_u32 s13, s87, 14
s_cmp_ge_u32 s13, 12
s_cselect_b32 s7, 6, 12
s_cselect_b32 s24, 12, 0
s_mul_i32 s7, s7, s6
s_add_u32 s13, s13, s7
s_add_u32 s13, s13, s24
s_cmp_lt_u32 s13, 12
s_cbranch_scc1 BC_job
s_mov_b32 s96, s40
s_and_b32 s97, s41, 0xffff
s_mov_b32 s98, 294912
s_mov_b32 s99, 0x20000
s_sub_u32 s6, s13, 12
s_mul_i32 s6, s6, 12288
s_add_u32 s7, s6, 6144
v_lshlrev_b32 v4, 7, v3
s_mov_b32 exec_hi, 0xffff
buffer_load_dword v44, v4, s[96:99], s6 offen
buffer_load_dword v45, v4, s[96:99], s7 offen
s_mov_b32 exec_hi, -1
s_cmp_lt_u32 s13, 24
s_cbranch_scc1 H_roles_done
BC_job:
s_mul_i32 s15, s86, 49152
s_lshl_b32 s14, s13, 10
s_add_u32 s14, s14, s15
s_add_u32 s14, s14, 12288
s_cmp_ge_u32 s13, 12
s_cbranch_scc1 BC_c
s_mul_i32 s17, s13, 49152
s_mov_b32 s18, 1.0
s_mov_b64 s[92:93], s[42:43]
s_mov_b32 s94, 589824
s_branch BC_go
BC_c:
s_add_u32 s15, s15, 12288
s_cmp_ge_u32 s13, 24
s_cselect_b64 s[92:93], s[38:39], s[36:37]
s_cselect_b32 s6, 24, 12
s_sub_u32 s6, s13, s6
s_mul_i32 s17, s6, 24576
s_mov_b32 s18, 0x3d96c740
s_mov_b32 s94, 294912
BC_go:
s_and_b32 s93, s93, 0xffff
s_mov_b32 s95, 0x20000
s_mul_i32 s21, s3, 24576
s_cmp_lt_u32 s13, 12
s_cbranch_scc0 BC_n
v_add_u32 v4, 0, v3
v_mul_u32_u24 v5, 1366, v4
v_lshrrev_b32 v5, 16, v5
v_lshlrev_b32 v4, 5, v5
v_xor_b32 v14, v8, v4
v_mul_u32_u24 v5, 768, v5
v_add_u32 v14, v14, v5
v_xor_b32 v17, 128, v14
v_add_u32 v4, 64, v3
v_mul_u32_u24 v5, 1366, v4
v_lshrrev_b32 v5, 16, v5
v_lshlrev_b32 v4, 5, v5
v_xor_b32 v15, v8, v4
v_mul_u32_u24 v5, 768, v5
v_add_u32 v15, v15, v5
v_xor_b32 v18, 128, v15
v_add_u32 v4, 128, v3
v_mul_u32_u24 v5, 1366, v4
v_lshrrev_b32 v5, 16, v5
v_lshlrev_b32 v4, 5, v5
v_xor_b32 v16, v8, v4
v_mul_u32_u24 v5, 768, v5
v_add_u32 v16, v16, v5
v_xor_b32 v19, 128, v16
s_add_u32 m0, s21, 0
s_nop 0
buffer_load_dwordx4 v14, s[92:95], s17 offen offset:0 lds
buffer_load_dwordx4 v15, s[92:95], s17 offen offset:1024 lds
buffer_load_dwordx4 v16, s[92:95], s17 offen offset:2048 lds
s_add_u32 s17, s17, 6144
s_add_u32 m0, s21, 3072
s_nop 0
buffer_load_dwordx4 v14, s[92:95], s17 offen offset:0 lds
buffer_load_dwordx4 v15, s[92:95], s17 offen offset:1024 lds
buffer_load_dwordx4 v16, s[92:95], s17 offen offset:2048 lds
s_add_u32 s17, s17, 6144
s_add_u32 m0, s21, 6144
s_nop 0
buffer_load_dwordx4 v17, s[92:95], s17 offen offset:0 lds
buffer_load_dwordx4 v18, s[92:95], s17 offen offset:1024 lds
buffer_load_dwordx4 v19, s[92:95], s17 offen offset:2048 lds
s_add_u32 s17, s17, 6144
s_add_u32 m0, s21, 9216
s_nop 0
buffer_load_dwordx4 v17, s[92:95], s17 offen offset:0 lds
buffer_load_dwordx4 v18, s[92:95], s17 offen offset:1024 lds
buffer_load_dwordx4 v19, s[92:95], s17 offen offset:2048 lds
s_add_u32 s17, s17, 6144
s_add_u32 m0, s21, 12288
s_nop 0
buffer_load_dwordx4 v14, s[92:95], s17 offen offset:0 lds
buffer_load_dwordx4 v15, s[92:95], s17 offen offset:1024 lds
buffer_load_dwordx4 v16, s[92:95], s17 offen offset:2048 lds
s_add_u32 s17, s17, 6144
s_add_u32 m0, s21, 15360
s_nop 0
buffer_load_dwordx4 v14, s[92:95], s17 offen offset:0 lds
buffer_load_dwordx4 v15, s[92:95], s17 offen offset:1024 lds
buffer_load_dwordx4 v16, s[92:95], s17 offen offset:2048 lds
s_add_u32 s17, s17, 6144
s_add_u32 m0, s21, 18432
s_nop 0
buffer_load_dwordx4 v17, s[92:95], s17 offen offset:0 lds
buffer_load_dwordx4 v18, s[92:95], s17 offen offset:1024 lds
buffer_load_dwordx4 v19, s[92:95], s17 offen offset:2048 lds
s_add_u32 s17, s17, 6144
s_add_u32 m0, s21, 21504
s_nop 0
buffer_load_dwordx4 v17, s[92:95], s17 offen offset:0 lds
buffer_load_dwordx4 v18, s[92:95], s17 offen offset:1024 lds
buffer_load_dwordx4 v19, s[92:95], s17 offen offset:2048 lds
s_add_u32 s17, s17, 6144
s_branch BC_l
BC_n:
v_add_u32 v4, 0, v3
v_mul_u32_u24 v5, 1366, v4
v_lshrrev_b32 v5, 16, v5
v_lshlrev_b32 v4, 5, v5
v_xor_b32 v14, v8, v4
v_xor_b32 v17, 128, v14
v_add_u32 v4, 64, v3
v_mul_u32_u24 v5, 1366, v4
v_lshrrev_b32 v5, 16, v5
v_lshlrev_b32 v4, 5, v5
v_xor_b32 v15, v8, v4
v_xor_b32 v18, 128, v15
v_add_u32 v4, 128, v3
v_mul_u32_u24 v5, 1366, v4
v_lshrrev_b32 v5, 16, v5
v_lshlrev_b32 v4, 5, v5
v_xor_b32 v16, v8, v4
v_xor_b32 v19, 128, v16
s_add_u32 m0, s21, 0
s_nop 0
buffer_load_dwordx4 v14, s[92:95], s17 offen offset:0 lds
buffer_load_dwordx4 v15, s[92:95], s17 offen offset:1024 lds
buffer_load_dwordx4 v16, s[92:95], s17 offen offset:2048 lds
s_add_u32 s17, s17, 3072
s_add_u32 m0, s21, 3072
s_nop 0
buffer_load_dwordx4 v14, s[92:95], s17 offen offset:0 lds
buffer_load_dwordx4 v15, s[92:95], s17 offen offset:1024 lds
buffer_load_dwordx4 v16, s[92:95], s17 offen offset:2048 lds
s_add_u32 s17, s17, 3072
s_add_u32 m0, s21, 6144
s_nop 0
buffer_load_dwordx4 v17, s[92:95], s17 offen offset:0 lds
buffer_load_dwordx4 v18, s[92:95], s17 offen offset:1024 lds
buffer_load_dwordx4 v19, s[92:95], s17 offen offset:2048 lds
s_add_u32 s17, s17, 3072
s_add_u32 m0, s21, 9216
s_nop 0
buffer_load_dwordx4 v17, s[92:95], s17 offen offset:0 lds
buffer_load_dwordx4 v18, s[92:95], s17 offen offset:1024 lds
buffer_load_dwordx4 v19, s[92:95], s17 offen offset:2048 lds
s_add_u32 s17, s17, 3072
s_add_u32 m0, s21, 12288
s_nop 0
buffer_load_dwordx4 v14, s[92:95], s17 offen offset:0 lds
buffer_load_dwordx4 v15, s[92:95], s17 offen offset:1024 lds
buffer_load_dwordx4 v16, s[92:95], s17 offen offset:2048 lds
s_add_u32 s17, s17, 3072
s_add_u32 m0, s21, 15360
s_nop 0
buffer_load_dwordx4 v14, s[92:95], s17 offen offset:0 lds
buffer_load_dwordx4 v15, s[92:95], s17 offen offset:1024 lds
buffer_load_dwordx4 v16, s[92:95], s17 offen offset:2048 lds
s_add_u32 s17, s17, 3072
s_add_u32 m0, s21, 18432
s_nop 0
buffer_load_dwordx4 v17, s[92:95], s17 offen offset:0 lds
buffer_load_dwordx4 v18, s[92:95], s17 offen offset:1024 lds
buffer_load_dwordx4 v19, s[92:95], s17 offen offset:2048 lds
s_add_u32 s17, s17, 3072
s_add_u32 m0, s21, 21504
s_nop 0
buffer_load_dwordx4 v17, s[92:95], s17 offen offset:0 lds
buffer_load_dwordx4 v18, s[92:95], s17 offen offset:1024 lds
buffer_load_dwordx4 v19, s[92:95], s17 offen offset:2048 lds
s_add_u32 s17, s17, 3072
BC_l:
v_lshrrev_b32 v4, 2, v1
v_and_b32 v5, 3, v1
v_lshl_add_u32 v4, v4, 3, v5
v_mul_u32_u24 v4, 768, v4
v_and_b32 v5, 7, v1
v_lshlrev_b32 v5, 1, v5
v_xor_b32 v5, v5, v2
v_lshl_add_u32 v4, v5, 4, v4
v_add_u32 v32, s21, v4
v_xor_b32 v33, 64, v32
v_xor_b32 v34, 128, v32
v_xor_b32 v35, 192, v32
s_waitcnt vmcnt(0)
ds_read_b128 v[112:115], v32 offset:0
ds_read_b128 v[160:163], v32 offset:3072
ds_read_b128 v[116:119], v33 offset:0
ds_read_b128 v[164:167], v33 offset:3072
ds_read_b128 v[120:123], v34 offset:0
ds_read_b128 v[168:171], v34 offset:3072
s_waitcnt lgkmcnt(6)
ds_read_b128 v[124:127], v35 offset:0
ds_read_b128 v[172:175], v35 offset:3072
ds_read_b128 v[128:131], v32 offset:256
ds_read_b128 v[176:179], v32 offset:3328
ds_read_b128 v[132:135], v33 offset:256
ds_read_b128 v[180:183], v33 offset:3328
s_waitcnt lgkmcnt(6)
ds_read_b128 v[136:139], v34 offset:256
ds_read_b128 v[184:187], v34 offset:3328
ds_read_b128 v[140:143], v35 offset:256
ds_read_b128 v[188:191], v35 offset:3328
ds_read_b128 v[144:147], v32 offset:512
ds_read_b128 v[192:195], v32 offset:3584
s_waitcnt lgkmcnt(6)
ds_read_b128 v[148:151], v33 offset:512
ds_read_b128 v[196:199], v33 offset:3584
ds_read_b128 v[152:155], v34 offset:512
ds_read_b128 v[200:203], v34 offset:3584
ds_read_b128 v[156:159], v35 offset:512
ds_read_b128 v[204:207], v35 offset:3584
s_waitcnt lgkmcnt(6)
s_add_u32 s16, s15, 4096
s_add_u32 s17, s15, 8192
s_cmp_lt_u32 s13, 12
s_cbranch_scc0 BC_w1
s_lshl_b32 s24, s86, 7
s_mov_b32 s30, 2097152
W4:
buffer_load_dwordx2 v[44:45], off, s[88:91], s24 sc1
s_sub_u32 s30, s30, 1
s_cselect_b32 s25, 0, 1
s_waitcnt vmcnt(0)
v_cmp_gt_u32 vcc, s25, v44
s_cbranch_vccnz W4
s_branch BC_w2
BC_w1:
s_lshl_b32 s24, s86, 7
s_mov_b32 s30, 2097152
W5:
buffer_load_dwordx2 v[44:45], off, s[88:91], s24 sc1
s_sub_u32 s30, s30, 1
s_cselect_b32 s25, 0, 1
s_waitcnt vmcnt(0)
v_min_u32 v44, v44, v45
v_cmp_gt_u32 vcc, s25, v44
s_cbranch_vccnz W5
BC_w2:
s_waitcnt lgkmcnt(0)
s_mov_b32 s30, 2097152
BC_poll:
buffer_load_dwordx4 v[64:67], v8, s[32:35], s15 offen offset:0 sc1
buffer_load_dwordx4 v[68:71], v8, s[32:35], s15 offen offset:1024 sc1
buffer_load_dwordx4 v[72:75], v8, s[32:35], s15 offen offset:2048 sc1
buffer_load_dwordx4 v[76:79], v8, s[32:35], s15 offen offset:3072 sc1
buffer_load_dwordx4 v[80:83], v8, s[32:35], s16 offen offset:0 sc1
buffer_load_dwordx4 v[84:87], v8, s[32:35], s16 offen offset:1024 sc1
buffer_load_dwordx4 v[88:91], v8, s[32:35], s16 offen offset:2048 sc1
buffer_load_dwordx4 v[92:95], v8, s[32:35], s16 offen offset:3072 sc1
buffer_load_dwordx4 v[96:99], v8, s[32:35], s17 offen offset:0 sc1
buffer_load_dwordx4 v[100:103], v8, s[32:35], s17 offen offset:1024 sc1
buffer_load_dwordx4 v[104:107], v8, s[32:35], s17 offen offset:2048 sc1
buffer_load_dwordx4 v[108:111], v8, s[32:35], s17 offen offset:3072 sc1
s_waitcnt vmcnt(11)
v_mfma_f32_16x16x32_bf16 v[24:27], v[112:115], v[64:67], 0
v_mfma_f32_16x16x32_bf16 v[28:31], v[160:163], v[64:67], 0
s_waitcnt vmcnt(10)
v_mfma_f32_16x16x32_bf16 v[24:27], v[116:119], v[68:71], v[24:27]
v_mfma_f32_16x16x32_bf16 v[28:31], v[164:167], v[68:71], v[28:31]
s_waitcnt vmcnt(9)
v_mfma_f32_16x16x32_bf16 v[24:27], v[120:123], v[72:75], v[24:27]
v_mfma_f32_16x16x32_bf16 v[28:31], v[168:171], v[72:75], v[28:31]
s_waitcnt vmcnt(8)
v_mfma_f32_16x16x32_bf16 v[24:27], v[124:127], v[76:79], v[24:27]
v_mfma_f32_16x16x32_bf16 v[28:31], v[172:175], v[76:79], v[28:31]
s_waitcnt vmcnt(7)
v_mfma_f32_16x16x32_bf16 v[24:27], v[128:131], v[80:83], v[24:27]
v_mfma_f32_16x16x32_bf16 v[28:31], v[176:179], v[80:83], v[28:31]
s_waitcnt vmcnt(6)
v_mfma_f32_16x16x32_bf16 v[24:27], v[132:135], v[84:87], v[24:27]
v_mfma_f32_16x16x32_bf16 v[28:31], v[180:183], v[84:87], v[28:31]
s_waitcnt vmcnt(5)
v_mfma_f32_16x16x32_bf16 v[24:27], v[136:139], v[88:91], v[24:27]
v_mfma_f32_16x16x32_bf16 v[28:31], v[184:187], v[88:91], v[28:31]
s_waitcnt vmcnt(4)
v_mfma_f32_16x16x32_bf16 v[24:27], v[140:143], v[92:95], v[24:27]
v_mfma_f32_16x16x32_bf16 v[28:31], v[188:191], v[92:95], v[28:31]
s_waitcnt vmcnt(3)
v_mfma_f32_16x16x32_bf16 v[24:27], v[144:147], v[96:99], v[24:27]
v_mfma_f32_16x16x32_bf16 v[28:31], v[192:195], v[96:99], v[28:31]
s_waitcnt vmcnt(2)
v_mfma_f32_16x16x32_bf16 v[24:27], v[148:151], v[100:103], v[24:27]
v_mfma_f32_16x16x32_bf16 v[28:31], v[196:199], v[100:103], v[28:31]
s_waitcnt vmcnt(1)
v_mfma_f32_16x16x32_bf16 v[24:27], v[152:155], v[104:107], v[24:27]
v_mfma_f32_16x16x32_bf16 v[28:31], v[200:203], v[104:107], v[28:31]
s_waitcnt vmcnt(0)
v_mfma_f32_16x16x32_bf16 v[24:27], v[156:159], v[108:111], v[24:27]
v_mfma_f32_16x16x32_bf16 v[28:31], v[204:207], v[108:111], v[28:31]
s_nop 6
v_cmp_u_f32 vcc, v24, v24
s_cbranch_vccnz BC_fix
BC_ok:
v_mul_f32 v24, s18, v24
v_mul_f32 v25, s18, v25
v_mul_f32 v26, s18, v26
v_mul_f32 v27, s18, v27
v_mul_f32 v28, s18, v28
v_mul_f32 v29, s18, v29
v_mul_f32 v30, s18, v30
v_mul_f32 v31, s18, v31
v_cvt_pk_bf16_f32 v40, v24, v25
v_cvt_pk_bf16_f32 v41, v26, v27
v_cvt_pk_bf16_f32 v42, v28, v29
v_cvt_pk_bf16_f32 v43, v30, v31
s_cmp_lt_u32 s13, 12
s_cbranch_scc1 BC_loc
buffer_store_dwordx4 v[40:43], v8, s[32:35], s14 offen sc1
s_branch BC_e
BC_loc:
buffer_store_dwordx4 v[40:43], v8, s[32:35], s14 offen
s_mov_b32 s100, s14
s_mov_b32 s101, 2
BC_e:
s_branch H_roles_done
BC_fix:
s_sub_u32 s30, s30, 1
s_cbranch_scc1 BC_ok
s_and_b32 s25, s30, 63
s_cbranch_scc1 BC_poll
v_max3_u32 v5, v64, v65, v66
v_max3_u32 v5, v5, v67, v68
v_max3_u32 v5, v5, v69, v70
v_max3_u32 v5, v5, v71, v72
v_max3_u32 v5, v5, v73, v74
v_max3_u32 v5, v5, v75, v76
v_max3_u32 v5, v5, v77, v78
v_max3_u32 v5, v5, v79, v80
v_max3_u32 v5, v5, v81, v82
v_max3_u32 v5, v5, v83, v84
v_max3_u32 v5, v5, v85, v86
v_max3_u32 v5, v5, v87, v88
v_max3_u32 v5, v5, v89, v90
v_max3_u32 v5, v5, v91, v92
v_max3_u32 v5, v5, v93, v94
v_max3_u32 v5, v5, v95, v96
v_max3_u32 v5, v5, v97, v98
v_max3_u32 v5, v5, v99, v100
v_max3_u32 v5, v5, v101, v102
v_max3_u32 v5, v5, v103, v104
v_max3_u32 v5, v5, v105, v106
v_max3_u32 v5, v5, v107, v108
v_max3_u32 v5, v5, v109, v110
v_max_u32 v5, v5, v111
v_cmp_eq_u32 vcc, -1, v5
s_cbranch_vccnz BC_poll
s_branch BC_ok
H_roles_done:
s_waitcnt lgkmcnt(0)
s_mov_b32 s96, s42
s_and_b32 s97, s43, 0xffff
s_mov_b32 s98, 589824
s_mov_b32 s99, 0x20000
s_mov_b32 s60, s36
s_and_b32 s61, s37, 0xffff
s_mov_b32 s62, 294912
s_mov_b32 s63, 0x20000
s_mov_b32 s64, s38
s_and_b32 s65, s39, 0xffff
s_mov_b32 s66, 294912
s_mov_b32 s67, 0x20000
s_mov_b32 s56, s44
s_and_b32 s57, s45, 0xffff
s_mov_b32 s58, 294912
s_mov_b32 s59, 0x20000
s_mov_b32 s12, s46
s_and_b32 s13, s47, 0xffff
s_mov_b32 s14, 1179648
s_mov_b32 s15, 0x20000
s_mov_b32 s16, s48
s_and_b32 s17, s49, 0xffff
s_mov_b32 s18, 1179648
s_mov_b32 s19, 0x20000
s_mov_b32 s20, s50
s_and_b32 s21, s51, 0xffff
s_mov_b32 s22, 24576
s_mov_b32 s23, 0x20000
s_lshr_b32 s36, s2, 3
s_and_b32 s37, s2, 7
s_waitcnt vmcnt(0) lgkmcnt(0)
s_barrier
s_sub_u32 s7, s87, 14
s_add_u32 s6, s87, 12
s_cmp_lt_u32 s7, 12
s_cselect_b32 s7, s7, s6
s_cmp_ge_u32 s7, 18
s_cbranch_scc1 H_t2no
s_mul_i32 s38, s7, 10923
s_lshr_b32 s38, s38, 16
s_mul_i32 s6, s38, 6
s_sub_u32 s39, s7, s6
s_mul_i32 s6, s86, 6
s_add_u32 s39, s39, s6
s_lshl_b32 s41, s39, 6
s_mul_i32 s6, s3, 36864
s_add_u32 s6, s6, s41
s_mul_i32 s7, s3, 3072
s_add_u32 m0, s7, 0
s_nop 0
buffer_load_dwordx4 v10, s[56:59], s6 offen lds
s_add_u32 s6, s6, 12288
s_add_u32 m0, s7, 1024
s_nop 0
buffer_load_dwordx4 v10, s[56:59], s6 offen lds
s_add_u32 s6, s6, 12288
s_add_u32 m0, s7, 2048
s_nop 0
buffer_load_dwordx4 v10, s[56:59], s6 offen lds
v_add_u32 v4, 0, v3
v_mul_u32_u24 v5, 1366, v4
v_lshrrev_b32 v5, 16, v5
v_lshlrev_b32 v4, 5, v5
v_xor_b32 v14, v8, v4
v_mul_u32_u24 v5, 768, v5
v_add_u32 v14, v14, v5
v_xor_b32 v17, 128, v14
v_add_u32 v4, 64, v3
v_mul_u32_u24 v5, 1366, v4
v_lshrrev_b32 v5, 16, v5
v_lshlrev_b32 v4, 5, v5
v_xor_b32 v15, v8, v4
v_mul_u32_u24 v5, 768, v5
v_add_u32 v15, v15, v5
v_xor_b32 v18, 128, v15
v_add_u32 v4, 128, v3
v_mul_u32_u24 v5, 1366, v4
v_lshrrev_b32 v5, 16, v5
v_lshlrev_b32 v4, 5, v5
v_xor_b32 v16, v8, v4
v_mul_u32_u24 v5, 768, v5
v_add_u32 v16, v16, v5
v_xor_b32 v19, 128, v16
s_mul_i32 s42, s38, 8
s_add_u32 s42, s42, s3
s_mul_i32 s43, s42, 24576
s_add_u32 s43, s43, 768
s_mul_i32 s47, s3, 12288
s_add_u32 s47, s47, 24576
s_add_u32 m0, s47, 0
s_nop 0
buffer_load_dwordx4 v14, s[96:99], s43 offen offset:0 lds
buffer_load_dwordx4 v15, s[96:99], s43 offen offset:1024 lds
buffer_load_dwordx4 v16, s[96:99], s43 offen offset:2048 lds
s_add_u32 s43, s43, 6144
s_add_u32 m0, s47, 3072
s_nop 0
buffer_load_dwordx4 v14, s[96:99], s43 offen offset:0 lds
buffer_load_dwordx4 v15, s[96:99], s43 offen offset:1024 lds
buffer_load_dwordx4 v16, s[96:99], s43 offen offset:2048 lds
s_add_u32 s43, s43, 6144
s_add_u32 m0, s47, 6144
s_nop 0
buffer_load_dwordx4 v17, s[96:99], s43 offen offset:0 lds
buffer_load_dwordx4 v18, s[96:99], s43 offen offset:1024 lds
buffer_load_dwordx4 v19, s[96:99], s43 offen offset:2048 lds
s_add_u32 s43, s43, 6144
s_add_u32 m0, s47, 9216
s_nop 0
buffer_load_dwordx4 v17, s[96:99], s43 offen offset:0 lds
buffer_load_dwordx4 v18, s[96:99], s43 offen offset:1024 lds
buffer_load_dwordx4 v19, s[96:99], s43 offen offset:2048 lds
s_add_u32 s43, s43, 6144
s_lshr_b32 s6, s3, 1
s_mul_i32 s6, s6, 24576
s_add_u32 s6, s6, 24576
v_lshrrev_b32 v4, 2, v1
v_and_b32 v5, 3, v1
v_lshl_add_u32 v4, v4, 3, v5
v_mul_u32_u24 v4, 768, v4
v_and_b32 v5, 7, v1
v_lshlrev_b32 v5, 1, v5
v_xor_b32 v5, v5, v2
v_lshl_add_u32 v4, v5, 4, v4
v_add_u32 v32, s6, v4
v_xor_b32 v33, 64, v32
v_xor_b32 v34, 128, v32
v_xor_b32 v35, 192, v32
v_lshrrev_b32 v4, 2, v1
v_and_b32 v5, 3, v1
v_lshl_add_u32 v4, v2, 3, v4
v_lshlrev_b32 v4, 6, v4
v_lshl_add_u32 v4, v5, 3, v4
s_and_b32 s44, s3, 1
s_lshl_b32 s6, s44, 5
v_add_u32 v4, s6, v4
v_and_b32 v5, 1, v1
v_mul_u32_u24 v5, 12288, v5
v_lshrrev_b32 v9, 1, v1
v_lshl_add_u32 v5, v9, 4, v5
v_lshl_add_u32 v5, v2, 8, v5
s_lshr_b32 s6, s42, 1
s_lshl_b32 s6, s6, 10
s_mul_i32 s7, s39, 24576
s_add_u32 s6, s6, s7
s_lshl_b32 s7, s44, 7
s_add_u32 s6, s6, s7
s_add_u32 s45, s6, 131072
s_waitcnt vmcnt(0)
s_barrier
ds_read_b64_tr_b16 v[64:65], v4 offset:0
ds_read_b64_tr_b16 v[66:67], v4 offset:256
ds_read_b128 v[112:115], v32 offset:0
ds_read_b128 v[160:163], v32 offset:3072
ds_read_b64_tr_b16 v[68:69], v4 offset:2048
ds_read_b64_tr_b16 v[70:71], v4 offset:2304
ds_read_b128 v[116:119], v33 offset:0
ds_read_b128 v[164:167], v33 offset:3072
s_waitcnt lgkmcnt(6)
ds_read_b64_tr_b16 v[72:73], v4 offset:4096
ds_read_b64_tr_b16 v[74:75], v4 offset:4352
ds_read_b128 v[120:123], v34 offset:0
ds_read_b128 v[168:171], v34 offset:3072
ds_read_b64_tr_b16 v[76:77], v4 offset:6144
ds_read_b64_tr_b16 v[78:79], v4 offset:6400
ds_read_b128 v[124:127], v35 offset:0
ds_read_b128 v[172:175], v35 offset:3072
s_waitcnt lgkmcnt(6)
ds_read_b64_tr_b16 v[80:81], v4 offset:8192
ds_read_b64_tr_b16 v[82:83], v4 offset:8448
ds_read_b128 v[128:131], v32 offset:256
ds_read_b128 v[176:179], v32 offset:3328
ds_read_b64_tr_b16 v[84:85], v4 offset:10240
ds_read_b64_tr_b16 v[86:87], v4 offset:10496
ds_read_b128 v[132:135], v33 offset:256
ds_read_b128 v[180:183], v33 offset:3328
s_waitcnt lgkmcnt(6)
ds_read_b64_tr_b16 v[88:89], v4 offset:12288
ds_read_b64_tr_b16 v[90:91], v4 offset:12544
ds_read_b128 v[136:139], v34 offset:256
ds_read_b128 v[184:187], v34 offset:3328
ds_read_b64_tr_b16 v[92:93], v4 offset:14336
ds_read_b64_tr_b16 v[94:95], v4 offset:14592
ds_read_b128 v[140:143], v35 offset:256
ds_read_b128 v[188:191], v35 offset:3328
s_waitcnt lgkmcnt(6)
ds_read_b64_tr_b16 v[96:97], v4 offset:16384
ds_read_b64_tr_b16 v[98:99], v4 offset:16640
ds_read_b128 v[144:147], v32 offset:512
ds_read_b128 v[192:195], v32 offset:3584
ds_read_b64_tr_b16 v[100:101], v4 offset:18432
ds_read_b64_tr_b16 v[102:103], v4 offset:18688
ds_read_b128 v[148:151], v33 offset:512
ds_read_b128 v[196:199], v33 offset:3584
s_waitcnt lgkmcnt(6)
ds_read_b64_tr_b16 v[104:105], v4 offset:20480
ds_read_b64_tr_b16 v[106:107], v4 offset:20736
ds_read_b128 v[152:155], v34 offset:512
ds_read_b128 v[200:203], v34 offset:3584
ds_read_b64_tr_b16 v[108:109], v4 offset:22528
ds_read_b64_tr_b16 v[110:111], v4 offset:22784
ds_read_b128 v[156:159], v35 offset:512
ds_read_b128 v[204:207], v35 offset:3584
s_waitcnt lgkmcnt(6)
s_waitcnt lgkmcnt(0)
v_mfma_f32_16x16x32_bf16 v[24:27], v[112:115], v[64:67], 0
v_mfma_f32_16x16x32_bf16 v[28:31], v[160:163], v[64:67], 0
v_mfma_f32_16x16x32_bf16 v[24:27], v[116:119], v[68:71], v[24:27]
v_mfma_f32_16x16x32_bf16 v[28:31], v[164:167], v[68:71], v[28:31]
v_mfma_f32_16x16x32_bf16 v[24:27], v[120:123], v[72:75], v[24:27]
v_mfma_f32_16x16x32_bf16 v[28:31], v[168:171], v[72:75], v[28:31]
v_mfma_f32_16x16x32_bf16 v[24:27], v[124:127], v[76:79], v[24:27]
v_mfma_f32_16x16x32_bf16 v[28:31], v[172:175], v[76:79], v[28:31]
v_mfma_f32_16x16x32_bf16 v[24:27], v[128:131], v[80:83], v[24:27]
v_mfma_f32_16x16x32_bf16 v[28:31], v[176:179], v[80:83], v[28:31]
v_mfma_f32_16x16x32_bf16 v[24:27], v[132:135], v[84:87], v[24:27]
v_mfma_f32_16x16x32_bf16 v[28:31], v[180:183], v[84:87], v[28:31]
v_mfma_f32_16x16x32_bf16 v[24:27], v[136:139], v[88:91], v[24:27]
v_mfma_f32_16x16x32_bf16 v[28:31], v[184:187], v[88:91], v[28:31]
v_mfma_f32_16x16x32_bf16 v[24:27], v[140:143], v[92:95], v[24:27]
v_mfma_f32_16x16x32_bf16 v[28:31], v[188:191], v[92:95], v[28:31]
v_mfma_f32_16x16x32_bf16 v[24:27], v[144:147], v[96:99], v[24:27]
v_mfma_f32_16x16x32_bf16 v[28:31], v[192:195], v[96:99], v[28:31]
v_mfma_f32_16x16x32_bf16 v[24:27], v[148:151], v[100:103], v[24:27]
v_mfma_f32_16x16x32_bf16 v[28:31], v[196:199], v[100:103], v[28:31]
v_mfma_f32_16x16x32_bf16 v[24:27], v[152:155], v[104:107], v[24:27]
v_mfma_f32_16x16x32_bf16 v[28:31], v[200:203], v[104:107], v[28:31]
v_mfma_f32_16x16x32_bf16 v[24:27], v[156:159], v[108:111], v[24:27]
v_mfma_f32_16x16x32_bf16 v[28:31], v[204:207], v[108:111], v[28:31]
s_nop 7
v_cvt_pk_bf16_f32 v24, v24, v25
v_cvt_pk_bf16_f32 v25, v26, v27
v_cvt_pk_bf16_f32 v26, v28, v29
v_cvt_pk_bf16_f32 v27, v30, v31
buffer_store_dwordx4 v[24:27], v5, s[32:35], s45 offen sc1
s_waitcnt vmcnt(0)
s_barrier
s_cmp_lg_u32 s3, 7
s_cbranch_scc1 H_t2done
s_mov_b32 s30, 2097152
W6:
buffer_load_dwordx2 v[44:45], off, s[88:91], 0 sc1
buffer_load_dwordx2 v[46:47], off, s[88:91], 0 offset:128 sc1
s_sub_u32 s30, s30, 1
s_cselect_b32 s25, 0, 1
s_waitcnt vmcnt(0)
v_min3_u32 v44, v44, v45, v46
v_min_u32 v44, v44, v47
v_cmp_gt_u32 vcc, s25, v44
s_cbranch_vccnz W6
s_mov_b32 s6, 1
s_atomic_add s6, s[54:55], 106496 glc
s_waitcnt lgkmcnt(0)
s_cmp_lg_u32 s6, 34
s_cbranch_scc1 G7
s_mov_b32 s6, 1
s_atomic_add s6, s[54:55], 122880
s_waitcnt lgkmcnt(0)
G7:
s_branch H_t2done
H_t2no:
H_t2done:
s_lshl_b32 s6, s3, 6
s_add_u32 s6, s6, s2
s_lshl_b32 s6, s6, 11
s_add_u32 s6, s6, 2097152
s_cmp_ge_u32 s6, 2908160
s_cbranch_scc1 H_nfill
buffer_store_dwordx4 v[20:23], v8, s[32:35], s6 offen offset:0 sc1
buffer_store_dwordx4 v[20:23], v8, s[32:35], s6 offen offset:1024 sc1
H_nfill:
s_and_b32 s6, s3, 1
s_lshl_b32 s6, s6, 2
v_add_u32 v4, 0, v3
v_mul_u32_u24 v5, 2731, v4
v_lshrrev_b32 v5, 16, v5
v_mul_u32_u24 v6, 24, v5
v_sub_u32 v6, v4, v6
v_and_b32 v7, 2, v5
v_xor_b32 v6, v6, v7
v_xor_b32 v6, s6, v6
v_lshlrev_b32 v6, 4, v6
v_mul_u32_u24 v5, 3072, v5
v_add_u32 v6, v6, v5
v_subrev_u32 v11, 0, v6
v_add_u32 v4, 64, v3
v_mul_u32_u24 v5, 2731, v4
v_lshrrev_b32 v5, 16, v5
v_mul_u32_u24 v6, 24, v5
v_sub_u32 v6, v4, v6
v_and_b32 v7, 2, v5
v_xor_b32 v6, v6, v7
v_xor_b32 v6, s6, v6
v_lshlrev_b32 v6, 4, v6
v_mul_u32_u24 v5, 3072, v5
v_add_u32 v6, v6, v5
v_subrev_u32 v12, 1024, v6
v_add_u32 v4, 128, v3
v_mul_u32_u24 v5, 2731, v4
v_lshrrev_b32 v5, 16, v5
v_mul_u32_u24 v6, 24, v5
v_sub_u32 v6, v4, v6
v_and_b32 v7, 2, v5
v_xor_b32 v6, v6, v7
v_xor_b32 v6, s6, v6
v_lshlrev_b32 v6, 4, v6
v_mul_u32_u24 v5, 3072, v5
v_add_u32 v6, v6, v5
v_subrev_u32 v13, 2048, v6
s_and_b32 s38, s36, 3
s_mul_i32 s38, s38, 12
s_add_u32 s38, s38, s3
s_mul_i32 s39, s37, 384
s_mov_b32 s40, 6
H_w1l:
s_cmp_ge_u32 s38, 48
s_cselect_b32 s6, 48, 0
s_sub_u32 s38, s38, s6
s_mul_i32 s6, s38, 24576
s_add_u32 s6, s6, s39
s_mul_i32 m0, s38, 3072
s_add_u32 s38, s38, 8
buffer_load_dwordx4 v11, s[12:15], s6 offen offset:0 lds
buffer_load_dwordx4 v12, s[12:15], s6 offen offset:1024 lds
buffer_load_dwordx4 v13, s[12:15], s6 offen offset:2048 lds
s_sub_u32 s40, s40, 1
s_cmp_lg_u32 s40, 0
s_cbranch_scc1 H_w1l
s_waitcnt vmcnt(0)
s_cmp_eq_u32 s101, 0
s_cbranch_scc1 H_fb
s_lshl_b32 s24, s86, 7
s_mov_b32 s30, 2097152
W8:
buffer_load_dwordx2 v[44:45], off, s[88:91], s24 sc1
s_sub_u32 s30, s30, 1
s_cselect_b32 s25, 0, 1
s_waitcnt vmcnt(0)
v_min_u32 v44, v44, v45
v_cmp_gt_u32 vcc, s25, v44
s_cbranch_vccnz W8
v_min_u32 v44, 23, v3
v_lshlrev_b32 v44, 10, v44
s_mul_i32 s24, s86, 49152
s_add_u32 s24, s24, 24576
s_mov_b32 s30, 0
W9:
buffer_load_dword v45, v44, s[32:35], s24 offen sc1
s_waitcnt vmcnt(0)
v_cmp_eq_u32 vcc, -1, v45
s_cbranch_vccz H_fb
s_sleep 4
s_sub_u32 s30, s30, 1
s_cbranch_scc0 W9
buffer_store_dwordx4 v[40:43], v8, s[32:35], s100 offen sc1
H_fb:
s_barrier
s_cmp_lg_u32 s3, 7
s_cbranch_scc1 H_nsig
s_mov_b32 s30, 2097152
W10:
buffer_load_dwordx2 v[44:45], off, s[88:91], 0 sc1
buffer_load_dwordx2 v[46:47], off, s[88:91], 0 offset:128 sc1
s_sub_u32 s30, s30, 1
s_cselect_b32 s25, 0, 1
s_waitcnt vmcnt(0)
v_min3_u32 v44, v44, v45, v46
v_min_u32 v44, v44, v47
v_cmp_gt_u32 vcc, s25, v44
s_cbranch_vccnz W10
s_lshl_b32 s26, s86, 10
s_add_u32 s26, s26, 120832
s_getreg_b32 s24, hwreg(HW_REG_XCC_ID, 0, 3)
s_lshl_b32 s24, s24, 3
s_lshl_b64 s[6:7], 1, s24
s_atomic_add_x2 s[6:7], s[54:55], s26 glc
s_waitcnt lgkmcnt(0)
s_mov_b32 s6, 1
s_atomic_add s6, s[54:55], 107520 glc
s_waitcnt lgkmcnt(0)
s_cmp_lg_u32 s6, 62
s_cbranch_scc1 G11
s_mov_b64 s[6:7], 64
s_atomic_add_x2 s[6:7], s[54:55], 114688
s_atomic_add_x2 s[6:7], s[54:55], 115712
s_atomic_add_x2 s[6:7], s[54:55], 116736
s_atomic_add_x2 s[6:7], s[54:55], 117760
s_waitcnt lgkmcnt(0)
s_atomic_add_x2 s[6:7], s[54:55], 118784
s_atomic_add_x2 s[6:7], s[54:55], 119808
s_atomic_add_x2 s[6:7], s[54:55], 120832
s_atomic_add_x2 s[6:7], s[54:55], 121856
s_waitcnt lgkmcnt(0)
G11:
H_nsig:
s_waitcnt lgkmcnt(0)
s_cmp_ge_u32 s3, 4
s_cbranch_scc1 H_now1
v_lshrrev_b32 v4, 2, v1
v_lshl_add_u32 v6, v2, 3, v4
v_mul_u32_u24 v6, 384, v6
v_and_b32 v5, 3, v1
v_lshl_add_u32 v6, v5, 3, v6
v_lshrrev_b32 v4, 1, v4
v_and_b32 v5, 1, v2
v_lshl_add_u32 v4, v5, 1, v4
s_mul_i32 s6, s3, 3
v_xor_b32 v5, s6, v4
v_lshl_add_u32 v32, v5, 5, v6
s_add_u32 s6, s6, 1
v_xor_b32 v5, s6, v4
v_lshl_add_u32 v33, v5, 5, v6
s_add_u32 s6, s6, 1
v_xor_b32 v5, s6, v4
v_lshl_add_u32 v34, v5, 5, v6
s_add_u32 s6, s6, 1
ds_read_b64_tr_b16 v[112:113], v32 offset:0
ds_read_b64_tr_b16 v[114:115], v32 offset:1536
ds_read_b64_tr_b16 v[160:161], v33 offset:0
ds_read_b64_tr_b16 v[162:163], v33 offset:1536
ds_read_b64_tr_b16 v[208:209], v34 offset:0
ds_read_b64_tr_b16 v[210:211], v34 offset:1536
s_waitcnt lgkmcnt(6)
ds_read_b64_tr_b16 v[116:117], v32 offset:12288
ds_read_b64_tr_b16 v[118:119], v32 offset:13824
ds_read_b64_tr_b16 v[164:165], v33 offset:12288
ds_read_b64_tr_b16 v[166:167], v33 offset:13824
ds_read_b64_tr_b16 v[212:213], v34 offset:12288
ds_read_b64_tr_b16 v[214:215], v34 offset:13824
s_waitcnt lgkmcnt(6)
ds_read_b64_tr_b16 v[120:121], v32 offset:24576
ds_read_b64_tr_b16 v[122:123], v32 offset:26112
ds_read_b64_tr_b16 v[168:169], v33 offset:24576
ds_read_b64_tr_b16 v[170:171], v33 offset:26112
ds_read_b64_tr_b16 v[216:217], v34 offset:24576
ds_read_b64_tr_b16 v[218:219], v34 offset:26112
s_waitcnt lgkmcnt(6)
ds_read_b64_tr_b16 v[124:125], v32 offset:36864
ds_read_b64_tr_b16 v[126:127], v32 offset:38400
ds_read_b64_tr_b16 v[172:173], v33 offset:36864
ds_read_b64_tr_b16 v[174:175], v33 offset:38400
ds_read_b64_tr_b16 v[220:221], v34 offset:36864
ds_read_b64_tr_b16 v[222:223], v34 offset:38400
s_waitcnt lgkmcnt(6)
v_add_u32 v32, 49152, v32
ds_read_b64_tr_b16 v[128:129], v32 offset:0
ds_read_b64_tr_b16 v[130:131], v32 offset:1536
v_add_u32 v33, 49152, v33
ds_read_b64_tr_b16 v[176:177], v33 offset:0
ds_read_b64_tr_b16 v[178:179], v33 offset:1536
v_add_u32 v34, 49152, v34
ds_read_b64_tr_b16 v[224:225], v34 offset:0
ds_read_b64_tr_b16 v[226:227], v34 offset:1536
s_waitcnt lgkmcnt(6)
ds_read_b64_tr_b16 v[132:133], v32 offset:12288
ds_read_b64_tr_b16 v[134:135], v32 offset:13824
ds_read_b64_tr_b16 v[180:181], v33 offset:12288
ds_read_b64_tr_b16 v[182:183], v33 offset:13824
ds_read_b64_tr_b16 v[228:229], v34 offset:12288
ds_read_b64_tr_b16 v[230:231], v34 offset:13824
s_waitcnt lgkmcnt(6)
ds_read_b64_tr_b16 v[136:137], v32 offset:24576
ds_read_b64_tr_b16 v[138:139], v32 offset:26112
ds_read_b64_tr_b16 v[184:185], v33 offset:24576
ds_read_b64_tr_b16 v[186:187], v33 offset:26112
ds_read_b64_tr_b16 v[232:233], v34 offset:24576
ds_read_b64_tr_b16 v[234:235], v34 offset:26112
s_waitcnt lgkmcnt(6)
ds_read_b64_tr_b16 v[140:141], v32 offset:36864
ds_read_b64_tr_b16 v[142:143], v32 offset:38400
ds_read_b64_tr_b16 v[188:189], v33 offset:36864
ds_read_b64_tr_b16 v[190:191], v33 offset:38400
ds_read_b64_tr_b16 v[236:237], v34 offset:36864
ds_read_b64_tr_b16 v[238:239], v34 offset:38400
s_waitcnt lgkmcnt(6)
v_add_u32 v32, 49152, v32
ds_read_b64_tr_b16 v[144:145], v32 offset:0
ds_read_b64_tr_b16 v[146:147], v32 offset:1536
v_add_u32 v33, 49152, v33
ds_read_b64_tr_b16 v[192:193], v33 offset:0
ds_read_b64_tr_b16 v[194:195], v33 offset:1536
v_add_u32 v34, 49152, v34
ds_read_b64_tr_b16 v[240:241], v34 offset:0
ds_read_b64_tr_b16 v[242:243], v34 offset:1536
s_waitcnt lgkmcnt(6)
ds_read_b64_tr_b16 v[148:149], v32 offset:12288
ds_read_b64_tr_b16 v[150:151], v32 offset:13824
ds_read_b64_tr_b16 v[196:197], v33 offset:12288
ds_read_b64_tr_b16 v[198:199], v33 offset:13824
ds_read_b64_tr_b16 v[244:245], v34 offset:12288
ds_read_b64_tr_b16 v[246:247], v34 offset:13824
s_waitcnt lgkmcnt(6)
ds_read_b64_tr_b16 v[152:153], v32 offset:24576
ds_read_b64_tr_b16 v[154:155], v32 offset:26112
ds_read_b64_tr_b16 v[200:201], v33 offset:24576
ds_read_b64_tr_b16 v[202:203], v33 offset:26112
ds_read_b64_tr_b16 v[248:249], v34 offset:24576
ds_read_b64_tr_b16 v[250:251], v34 offset:26112
s_waitcnt lgkmcnt(6)
ds_read_b64_tr_b16 v[156:157], v32 offset:36864
ds_read_b64_tr_b16 v[158:159], v32 offset:38400
ds_read_b64_tr_b16 v[204:205], v33 offset:36864
ds_read_b64_tr_b16 v[206:207], v33 offset:38400
ds_read_b64_tr_b16 v[252:253], v34 offset:36864
ds_read_b64_tr_b16 v[254:255], v34 offset:38400
s_waitcnt lgkmcnt(6)
s_waitcnt lgkmcnt(0)
H_now1:
v_add_u32 v4, 0, v3
v_mul_u32_u24 v5, 1366, v4
v_lshrrev_b32 v5, 16, v5
v_lshlrev_b32 v4, 5, v5
v_xor_b32 v14, v8, v4
v_xor_b32 v17, 128, v14
v_add_u32 v4, 64, v3
v_mul_u32_u24 v5, 1366, v4
v_lshrrev_b32 v5, 16, v5
v_lshlrev_b32 v4, 5, v5
v_xor_b32 v15, v8, v4
v_xor_b32 v18, 128, v15
v_add_u32 v4, 128, v3
v_mul_u32_u24 v5, 1366, v4
v_lshrrev_b32 v5, 16, v5
v_lshlrev_b32 v4, 5, v5
v_xor_b32 v16, v8, v4
v_xor_b32 v19, 128, v16
s_lshl_b32 s6, s3, 6
s_and_b32 s6, s6, 128
v_xor_b32 v14, s6, v14
v_xor_b32 v15, s6, v15
v_xor_b32 v16, s6, v16
s_bitcmp1_b32 s37, 2
s_cselect_b64 s[48:49], s[64:65], s[60:61]
s_mov_b32 s50, 294912
s_mov_b32 s51, 0x20000
s_and_b32 s6, s37, 1
s_lshl_b32 s6, s6, 4
s_bfe_u32 s7, s37, 0x10001
s_lshl_b32 s7, s7, 6
s_add_u32 s6, s6, s7
s_lshl_b32 s7, s3, 1
s_add_u32 s6, s6, s7
s_mul_i32 s6, s6, 768
s_mul_i32 s40, s3, 3072
v_add_u32 v4, 0, v3
v_mul_u32_u24 v5, 1366, v4
v_lshrrev_b32 v5, 16, v5
v_and_b32 v6, 1, v5
v_mul_u32_u24 v6, 23808, v6
v_lshrrev_b32 v5, 1, v5
v_mul_u32_u24 v5, 768, v5
v_add_u32 v6, 0, v6
v_sub_u32 v6, v6, v5
v_add_u32 v17, v14, v6
v_add_u32 v4, 64, v3
v_mul_u32_u24 v5, 1366, v4
v_lshrrev_b32 v5, 16, v5
v_and_b32 v6, 1, v5
v_mul_u32_u24 v6, 23808, v6
v_lshrrev_b32 v5, 1, v5
v_mul_u32_u24 v5, 768, v5
v_add_u32 v6, 1024, v6
v_sub_u32 v6, v6, v5
v_add_u32 v18, v15, v6
v_add_u32 v4, 128, v3
v_mul_u32_u24 v5, 1366, v4
v_lshrrev_b32 v5, 16, v5
v_and_b32 v6, 1, v5
v_mul_u32_u24 v6, 23808, v6
v_lshrrev_b32 v5, 1, v5
v_mul_u32_u24 v5, 768, v5
v_add_u32 v6, 2048, v6
v_sub_u32 v6, v6, v5
v_add_u32 v19, v16, v6
s_barrier
s_add_u32 m0, s40, 0
s_nop 0
buffer_load_dwordx4 v17, s[48:51], s6 offen lds
s_add_u32 m0, s40, 1024
s_nop 0
buffer_load_dwordx4 v18, s[48:51], s6 offen lds
s_add_u32 m0, s40, 2048
s_nop 0
buffer_load_dwordx4 v19, s[48:51], s6 offen lds
s_add_u32 s6, s6, 98304
s_add_u32 m0, s40, 24576
s_nop 0
buffer_load_dwordx4 v17, s[48:51], s6 offen lds
s_add_u32 m0, s40, 25600
s_nop 0
buffer_load_dwordx4 v18, s[48:51], s6 offen lds
s_add_u32 m0, s40, 26624
s_nop 0
buffer_load_dwordx4 v19, s[48:51], s6 offen lds
s_add_u32 s6, s6, 98304
s_add_u32 m0, s40, 49152
s_nop 0
buffer_load_dwordx4 v17, s[48:51], s6 offen lds
s_add_u32 m0, s40, 50176
s_nop 0
buffer_load_dwordx4 v18, s[48:51], s6 offen lds
s_add_u32 m0, s40, 51200
s_nop 0
buffer_load_dwordx4 v19, s[48:51], s6 offen lds
s_add_u32 s6, s6, 98304
s_waitcnt vmcnt(0)
s_barrier
s_cmp_lt_u32 s3, 4
s_cbranch_scc1 H_nowov
s_mov_b32 s30, 2097152
s_mov_b32 s24, 122880
W12:
buffer_load_dword v24, off, s[32:35], s24 sc1
s_sub_u32 s30, s30, 1
s_cbranch_scc1 W12x
s_waitcnt vmcnt(0)
v_cmp_eq_u32 vcc, -1, v24
s_cbranch_vccz W12x
s_sleep 4
s_branch W12
W12x:
s_mov_b32 s6, 0
v_lshrrev_b32 v4, 2, v1
v_and_b32 v5, 3, v1
v_lshl_add_u32 v4, v4, 3, v5
v_mul_u32_u24 v4, 768, v4
v_and_b32 v5, 7, v1
v_lshlrev_b32 v5, 1, v5
v_xor_b32 v5, v5, v2
v_lshl_add_u32 v4, v5, 4, v4
v_add_u32 v10, s6, v4
v_xor_b32 v11, 64, v10
v_xor_b32 v12, 128, v10
v_xor_b32 v13, 192, v10
s_sub_u32 s6, s3, 4
s_mul_i32 s39, s6, 73728
s_add_u32 s39, s39, 131072
s_mov_b32 s41, 3
buffer_load_dwordx4 v[112:115], v8, s[32:35], s39 offen offset:0 sc1
buffer_load_dwordx4 v[116:119], v8, s[32:35], s39 offen offset:1024 sc1
buffer_load_dwordx4 v[120:123], v8, s[32:35], s39 offen offset:2048 sc1
buffer_load_dwordx4 v[124:127], v8, s[32:35], s39 offen offset:3072 sc1
s_add_u32 s39, s39, 4096
buffer_load_dwordx4 v[128:131], v8, s[32:35], s39 offen offset:0 sc1
buffer_load_dwordx4 v[132:135], v8, s[32:35], s39 offen offset:1024 sc1
buffer_load_dwordx4 v[136:139], v8, s[32:35], s39 offen offset:2048 sc1
buffer_load_dwordx4 v[140:143], v8, s[32:35], s39 offen offset:3072 sc1
s_add_u32 s39, s39, 4096
buffer_load_dwordx4 v[144:147], v8, s[32:35], s39 offen offset:0 sc1
buffer_load_dwordx4 v[148:151], v8, s[32:35], s39 offen offset:1024 sc1
buffer_load_dwordx4 v[152:155], v8, s[32:35], s39 offen offset:2048 sc1
buffer_load_dwordx4 v[156:159], v8, s[32:35], s39 offen offset:3072 sc1
s_add_u32 s39, s39, 4096
H_wr:
v_mov_b32 v40, v64
v_mov_b32 v41, v65
v_mov_b32 v42, v66
v_mov_b32 v43, v67
v_mov_b32 v44, v68
v_mov_b32 v45, v69
v_mov_b32 v46, v70
v_mov_b32 v47, v71
v_mov_b32 v48, v72
v_mov_b32 v49, v73
v_mov_b32 v50, v74
v_mov_b32 v51, v75
v_mov_b32 v52, v76
v_mov_b32 v53, v77
v_mov_b32 v54, v78
v_mov_b32 v55, v79
v_mov_b32 v56, v80
v_mov_b32 v57, v81
v_mov_b32 v58, v82
v_mov_b32 v59, v83
v_mov_b32 v60, v84
v_mov_b32 v61, v85
v_mov_b32 v62, v86
v_mov_b32 v63, v87
v_mov_b32 v64, v88
v_mov_b32 v65, v89
v_mov_b32 v66, v90
v_mov_b32 v67, v91
v_mov_b32 v68, v92
v_mov_b32 v69, v93
v_mov_b32 v70, v94
v_mov_b32 v71, v95
v_mov_b32 v72, v96
v_mov_b32 v73, v97
v_mov_b32 v74, v98
v_mov_b32 v75, v99
v_mov_b32 v76, v100
v_mov_b32 v77, v101
v_mov_b32 v78, v102
v_mov_b32 v79, v103
v_mov_b32 v80, v104
v_mov_b32 v81, v105
v_mov_b32 v82, v106
v_mov_b32 v83, v107
v_mov_b32 v84, v108
v_mov_b32 v85, v109
v_mov_b32 v86, v110
v_mov_b32 v87, v111
buffer_load_dwordx4 v[160:163], v8, s[32:35], s39 offen offset:0 sc1
buffer_load_dwordx4 v[164:167], v8, s[32:35], s39 offen offset:1024 sc1
buffer_load_dwordx4 v[168:171], v8, s[32:35], s39 offen offset:2048 sc1
buffer_load_dwordx4 v[172:175], v8, s[32:35], s39 offen offset:3072 sc1
s_add_u32 s39, s39, 4096
buffer_load_dwordx4 v[176:179], v8, s[32:35], s39 offen offset:0 sc1
buffer_load_dwordx4 v[180:183], v8, s[32:35], s39 offen offset:1024 sc1
buffer_load_dwordx4 v[184:187], v8, s[32:35], s39 offen offset:2048 sc1
buffer_load_dwordx4 v[188:191], v8, s[32:35], s39 offen offset:3072 sc1
s_add_u32 s39, s39, 4096
buffer_load_dwordx4 v[192:195], v8, s[32:35], s39 offen offset:0 sc1
buffer_load_dwordx4 v[196:199], v8, s[32:35], s39 offen offset:1024 sc1
buffer_load_dwordx4 v[200:203], v8, s[32:35], s39 offen offset:2048 sc1
buffer_load_dwordx4 v[204:207], v8, s[32:35], s39 offen offset:3072 sc1
s_add_u32 s39, s39, 4096
s_waitcnt vmcnt(12)
ds_read_b128 v[208:211], v10 offset:0
ds_read_b128 v[212:215], v10 offset:3072
ds_read_b128 v[216:219], v11 offset:0
ds_read_b128 v[220:223], v11 offset:3072
ds_read_b128 v[224:227], v12 offset:0
ds_read_b128 v[228:231], v12 offset:3072
ds_read_b128 v[232:235], v13 offset:0
ds_read_b128 v[236:239], v13 offset:3072
ds_read_b128 v[240:243], v10 offset:256
ds_read_b128 v[244:247], v10 offset:3328
s_waitcnt lgkmcnt(8)
v_mfma_f32_16x16x32_bf16 v[24:27], v[208:211], v[112:115], 0
v_mfma_f32_16x16x32_bf16 v[28:31], v[212:215], v[112:115], 0
ds_read_b128 v[248:251], v11 offset:256
ds_read_b128 v[252:255], v11 offset:3328
s_waitcnt lgkmcnt(8)
v_mfma_f32_16x16x32_bf16 v[24:27], v[216:219], v[116:119], v[24:27]
v_mfma_f32_16x16x32_bf16 v[28:31], v[220:223], v[116:119], v[28:31]
ds_read_b128 v[208:211], v12 offset:256
ds_read_b128 v[212:215], v12 offset:3328
s_waitcnt lgkmcnt(8)
v_mfma_f32_16x16x32_bf16 v[24:27], v[224:227], v[120:123], v[24:27]
v_mfma_f32_16x16x32_bf16 v[28:31], v[228:231], v[120:123], v[28:31]
ds_read_b128 v[216:219], v13 offset:256
ds_read_b128 v[220:223], v13 offset:3328
s_waitcnt lgkmcnt(8)
v_mfma_f32_16x16x32_bf16 v[24:27], v[232:235], v[124:127], v[24:27]
v_mfma_f32_16x16x32_bf16 v[28:31], v[236:239], v[124:127], v[28:31]
ds_read_b128 v[224:227], v10 offset:512
ds_read_b128 v[228:231], v10 offset:3584
s_waitcnt lgkmcnt(8)
v_mfma_f32_16x16x32_bf16 v[24:27], v[240:243], v[128:131], v[24:27]
v_mfma_f32_16x16x32_bf16 v[28:31], v[244:247], v[128:131], v[28:31]
ds_read_b128 v[232:235], v11 offset:512
ds_read_b128 v[236:239], v11 offset:3584
s_waitcnt lgkmcnt(8)
v_mfma_f32_16x16x32_bf16 v[24:27], v[248:251], v[132:135], v[24:27]
v_mfma_f32_16x16x32_bf16 v[28:31], v[252:255], v[132:135], v[28:31]
ds_read_b128 v[240:243], v12 offset:512
ds_read_b128 v[244:247], v12 offset:3584
s_waitcnt lgkmcnt(8)
v_mfma_f32_16x16x32_bf16 v[24:27], v[208:211], v[136:139], v[24:27]
v_mfma_f32_16x16x32_bf16 v[28:31], v[212:215], v[136:139], v[28:31]
ds_read_b128 v[248:251], v13 offset:512
ds_read_b128 v[252:255], v13 offset:3584
s_waitcnt lgkmcnt(8)
v_mfma_f32_16x16x32_bf16 v[24:27], v[216:219], v[140:143], v[24:27]
v_mfma_f32_16x16x32_bf16 v[28:31], v[220:223], v[140:143], v[28:31]
ds_read_b128 v[208:211], v10 offset:24576
ds_read_b128 v[212:215], v10 offset:27648
s_waitcnt lgkmcnt(8)
v_mfma_f32_16x16x32_bf16 v[24:27], v[224:227], v[144:147], v[24:27]
v_mfma_f32_16x16x32_bf16 v[28:31], v[228:231], v[144:147], v[28:31]
ds_read_b128 v[216:219], v11 offset:24576
ds_read_b128 v[220:223], v11 offset:27648
s_waitcnt lgkmcnt(8)
v_mfma_f32_16x16x32_bf16 v[24:27], v[232:235], v[148:151], v[24:27]
v_mfma_f32_16x16x32_bf16 v[28:31], v[236:239], v[148:151], v[28:31]
ds_read_b128 v[224:227], v12 offset:24576
ds_read_b128 v[228:231], v12 offset:27648
s_waitcnt lgkmcnt(8)
v_mfma_f32_16x16x32_bf16 v[24:27], v[240:243], v[152:155], v[24:27]
v_mfma_f32_16x16x32_bf16 v[28:31], v[244:247], v[152:155], v[28:31]
ds_read_b128 v[232:235], v13 offset:24576
ds_read_b128 v[236:239], v13 offset:27648
s_waitcnt lgkmcnt(8)
v_mfma_f32_16x16x32_bf16 v[24:27], v[248:251], v[156:159], v[24:27]
v_mfma_f32_16x16x32_bf16 v[28:31], v[252:255], v[156:159], v[28:31]
ds_read_b128 v[240:243], v10 offset:24832
ds_read_b128 v[244:247], v10 offset:27904
s_waitcnt lgkmcnt(8)
v_mfma_f32_16x16x32_bf16 v[32:35], v[208:211], v[112:115], 0
v_mfma_f32_16x16x32_bf16 v[36:39], v[212:215], v[112:115], 0
ds_read_b128 v[248:251], v11 offset:24832
ds_read_b128 v[252:255], v11 offset:27904
s_waitcnt lgkmcnt(8)
v_mfma_f32_16x16x32_bf16 v[32:35], v[216:219], v[116:119], v[32:35]
v_mfma_f32_16x16x32_bf16 v[36:39], v[220:223], v[116:119], v[36:39]
ds_read_b128 v[208:211], v12 offset:24832
ds_read_b128 v[212:215], v12 offset:27904
s_waitcnt lgkmcnt(8)
v_mfma_f32_16x16x32_bf16 v[32:35], v[224:227], v[120:123], v[32:35]
v_mfma_f32_16x16x32_bf16 v[36:39], v[228:231], v[120:123], v[36:39]
ds_read_b128 v[216:219], v13 offset:24832
ds_read_b128 v[220:223], v13 offset:27904
s_waitcnt lgkmcnt(8)
v_mfma_f32_16x16x32_bf16 v[32:35], v[232:235], v[124:127], v[32:35]
v_mfma_f32_16x16x32_bf16 v[36:39], v[236:239], v[124:127], v[36:39]
ds_read_b128 v[224:227], v10 offset:25088
ds_read_b128 v[228:231], v10 offset:28160
v_cvt_pk_bf16_f32 v88, v24, v25
v_cvt_pk_bf16_f32 v89, v26, v27
v_cvt_pk_bf16_f32 v90, v28, v29
v_cvt_pk_bf16_f32 v91, v30, v31
s_waitcnt lgkmcnt(8)
v_mfma_f32_16x16x32_bf16 v[32:35], v[240:243], v[128:131], v[32:35]
v_mfma_f32_16x16x32_bf16 v[36:39], v[244:247], v[128:131], v[36:39]
ds_read_b128 v[232:235], v11 offset:25088
ds_read_b128 v[236:239], v11 offset:28160
s_waitcnt lgkmcnt(8)
v_mfma_f32_16x16x32_bf16 v[32:35], v[248:251], v[132:135], v[32:35]
v_mfma_f32_16x16x32_bf16 v[36:39], v[252:255], v[132:135], v[36:39]
ds_read_b128 v[240:243], v12 offset:25088
ds_read_b128 v[244:247], v12 offset:28160
s_waitcnt lgkmcnt(8)
v_mfma_f32_16x16x32_bf16 v[32:35], v[208:211], v[136:139], v[32:35]
v_mfma_f32_16x16x32_bf16 v[36:39], v[212:215], v[136:139], v[36:39]
ds_read_b128 v[248:251], v13 offset:25088
ds_read_b128 v[252:255], v13 offset:28160
s_waitcnt lgkmcnt(8)
v_mfma_f32_16x16x32_bf16 v[32:35], v[216:219], v[140:143], v[32:35]
v_mfma_f32_16x16x32_bf16 v[36:39], v[220:223], v[140:143], v[36:39]
ds_read_b128 v[208:211], v10 offset:49152
ds_read_b128 v[212:215], v10 offset:52224
s_waitcnt lgkmcnt(8)
v_mfma_f32_16x16x32_bf16 v[32:35], v[224:227], v[144:147], v[32:35]
v_mfma_f32_16x16x32_bf16 v[36:39], v[228:231], v[144:147], v[36:39]
ds_read_b128 v[216:219], v11 offset:49152
ds_read_b128 v[220:223], v11 offset:52224
s_waitcnt lgkmcnt(8)
v_mfma_f32_16x16x32_bf16 v[32:35], v[232:235], v[148:151], v[32:35]
v_mfma_f32_16x16x32_bf16 v[36:39], v[236:239], v[148:151], v[36:39]
ds_read_b128 v[224:227], v12 offset:49152
ds_read_b128 v[228:231], v12 offset:52224
s_waitcnt lgkmcnt(8)
v_mfma_f32_16x16x32_bf16 v[32:35], v[240:243], v[152:155], v[32:35]
v_mfma_f32_16x16x32_bf16 v[36:39], v[244:247], v[152:155], v[36:39]
ds_read_b128 v[232:235], v13 offset:49152
ds_read_b128 v[236:239], v13 offset:52224
s_waitcnt lgkmcnt(8)
v_mfma_f32_16x16x32_bf16 v[32:35], v[248:251], v[156:159], v[32:35]
v_mfma_f32_16x16x32_bf16 v[36:39], v[252:255], v[156:159], v[36:39]
ds_read_b128 v[240:243], v10 offset:49408
ds_read_b128 v[244:247], v10 offset:52480
s_waitcnt lgkmcnt(8)
v_mfma_f32_16x16x32_bf16 v[24:27], v[208:211], v[112:115], 0
v_mfma_f32_16x16x32_bf16 v[28:31], v[212:215], v[112:115], 0
ds_read_b128 v[248:251], v11 offset:49408
ds_read_b128 v[252:255], v11 offset:52480
s_waitcnt lgkmcnt(8)
v_mfma_f32_16x16x32_bf16 v[24:27], v[216:219], v[116:119], v[24:27]
v_mfma_f32_16x16x32_bf16 v[28:31], v[220:223], v[116:119], v[28:31]
ds_read_b128 v[208:211], v12 offset:49408
ds_read_b128 v[212:215], v12 offset:52480
s_waitcnt lgkmcnt(8)
v_mfma_f32_16x16x32_bf16 v[24:27], v[224:227], v[120:123], v[24:27]
v_mfma_f32_16x16x32_bf16 v[28:31], v[228:231], v[120:123], v[28:31]
ds_read_b128 v[216:219], v13 offset:49408
ds_read_b128 v[220:223], v13 offset:52480
s_waitcnt lgkmcnt(8)
v_mfma_f32_16x16x32_bf16 v[24:27], v[232:235], v[124:127], v[24:27]
v_mfma_f32_16x16x32_bf16 v[28:31], v[236:239], v[124:127], v[28:31]
ds_read_b128 v[224:227], v10 offset:49664
ds_read_b128 v[228:231], v10 offset:52736
v_cvt_pk_bf16_f32 v92, v32, v33
v_cvt_pk_bf16_f32 v93, v34, v35
v_cvt_pk_bf16_f32 v94, v36, v37
v_cvt_pk_bf16_f32 v95, v38, v39
s_waitcnt lgkmcnt(8)
v_mfma_f32_16x16x32_bf16 v[24:27], v[240:243], v[128:131], v[24:27]
v_mfma_f32_16x16x32_bf16 v[28:31], v[244:247], v[128:131], v[28:31]
ds_read_b128 v[232:235], v11 offset:49664
ds_read_b128 v[236:239], v11 offset:52736
s_waitcnt lgkmcnt(8)
v_mfma_f32_16x16x32_bf16 v[24:27], v[248:251], v[132:135], v[24:27]
v_mfma_f32_16x16x32_bf16 v[28:31], v[252:255], v[132:135], v[28:31]
ds_read_b128 v[240:243], v12 offset:49664
ds_read_b128 v[244:247], v12 offset:52736
s_waitcnt lgkmcnt(8)
v_mfma_f32_16x16x32_bf16 v[24:27], v[208:211], v[136:139], v[24:27]
v_mfma_f32_16x16x32_bf16 v[28:31], v[212:215], v[136:139], v[28:31]
ds_read_b128 v[248:251], v13 offset:49664
ds_read_b128 v[252:255], v13 offset:52736
s_waitcnt lgkmcnt(8)
v_mfma_f32_16x16x32_bf16 v[24:27], v[216:219], v[140:143], v[24:27]
v_mfma_f32_16x16x32_bf16 v[28:31], v[220:223], v[140:143], v[28:31]
s_waitcnt lgkmcnt(6)
v_mfma_f32_16x16x32_bf16 v[24:27], v[224:227], v[144:147], v[24:27]
v_mfma_f32_16x16x32_bf16 v[28:31], v[228:231], v[144:147], v[28:31]
s_waitcnt lgkmcnt(4)
v_mfma_f32_16x16x32_bf16 v[24:27], v[232:235], v[148:151], v[24:27]
v_mfma_f32_16x16x32_bf16 v[28:31], v[236:239], v[148:151], v[28:31]
s_waitcnt lgkmcnt(2)
v_mfma_f32_16x16x32_bf16 v[24:27], v[240:243], v[152:155], v[24:27]
v_mfma_f32_16x16x32_bf16 v[28:31], v[244:247], v[152:155], v[28:31]
s_waitcnt lgkmcnt(0)
v_mfma_f32_16x16x32_bf16 v[24:27], v[248:251], v[156:159], v[24:27]
v_mfma_f32_16x16x32_bf16 v[28:31], v[252:255], v[156:159], v[28:31]
s_nop 7
v_cvt_pk_bf16_f32 v96, v24, v25
v_cvt_pk_bf16_f32 v97, v26, v27
v_cvt_pk_bf16_f32 v98, v28, v29
v_cvt_pk_bf16_f32 v99, v30, v31
buffer_load_dwordx4 v[112:115], v8, s[32:35], s39 offen offset:0 sc1
buffer_load_dwordx4 v[116:119], v8, s[32:35], s39 offen offset:1024 sc1
buffer_load_dwordx4 v[120:123], v8, s[32:35], s39 offen offset:2048 sc1
buffer_load_dwordx4 v[124:127], v8, s[32:35], s39 offen offset:3072 sc1
s_add_u32 s39, s39, 4096
buffer_load_dwordx4 v[128:131], v8, s[32:35], s39 offen offset:0 sc1
buffer_load_dwordx4 v[132:135], v8, s[32:35], s39 offen offset:1024 sc1
buffer_load_dwordx4 v[136:139], v8, s[32:35], s39 offen offset:2048 sc1
buffer_load_dwordx4 v[140:143], v8, s[32:35], s39 offen offset:3072 sc1
s_add_u32 s39, s39, 4096
buffer_load_dwordx4 v[144:147], v8, s[32:35], s39 offen offset:0 sc1
buffer_load_dwordx4 v[148:151], v8, s[32:35], s39 offen offset:1024 sc1
buffer_load_dwordx4 v[152:155], v8, s[32:35], s39 offen offset:2048 sc1
buffer_load_dwordx4 v[156:159], v8, s[32:35], s39 offen offset:3072 sc1
s_add_u32 s39, s39, 4096
s_waitcnt vmcnt(12)
ds_read_b128 v[208:211], v10 offset:0
ds_read_b128 v[212:215], v10 offset:3072
ds_read_b128 v[216:219], v11 offset:0
ds_read_b128 v[220:223], v11 offset:3072
ds_read_b128 v[224:227], v12 offset:0
ds_read_b128 v[228:231], v12 offset:3072
ds_read_b128 v[232:235], v13 offset:0
ds_read_b128 v[236:239], v13 offset:3072
ds_read_b128 v[240:243], v10 offset:256
ds_read_b128 v[244:247], v10 offset:3328
s_waitcnt lgkmcnt(8)
v_mfma_f32_16x16x32_bf16 v[24:27], v[208:211], v[160:163], 0
v_mfma_f32_16x16x32_bf16 v[28:31], v[212:215], v[160:163], 0
ds_read_b128 v[248:251], v11 offset:256
ds_read_b128 v[252:255], v11 offset:3328
s_waitcnt lgkmcnt(8)
v_mfma_f32_16x16x32_bf16 v[24:27], v[216:219], v[164:167], v[24:27]
v_mfma_f32_16x16x32_bf16 v[28:31], v[220:223], v[164:167], v[28:31]
ds_read_b128 v[208:211], v12 offset:256
ds_read_b128 v[212:215], v12 offset:3328
s_waitcnt lgkmcnt(8)
v_mfma_f32_16x16x32_bf16 v[24:27], v[224:227], v[168:171], v[24:27]
v_mfma_f32_16x16x32_bf16 v[28:31], v[228:231], v[168:171], v[28:31]
ds_read_b128 v[216:219], v13 offset:256
ds_read_b128 v[220:223], v13 offset:3328
s_waitcnt lgkmcnt(8)
v_mfma_f32_16x16x32_bf16 v[24:27], v[232:235], v[172:175], v[24:27]
v_mfma_f32_16x16x32_bf16 v[28:31], v[236:239], v[172:175], v[28:31]
ds_read_b128 v[224:227], v10 offset:512
ds_read_b128 v[228:231], v10 offset:3584
s_waitcnt lgkmcnt(8)
v_mfma_f32_16x16x32_bf16 v[24:27], v[240:243], v[176:179], v[24:27]
v_mfma_f32_16x16x32_bf16 v[28:31], v[244:247], v[176:179], v[28:31]
ds_read_b128 v[232:235], v11 offset:512
ds_read_b128 v[236:239], v11 offset:3584
s_waitcnt lgkmcnt(8)
v_mfma_f32_16x16x32_bf16 v[24:27], v[248:251], v[180:183], v[24:27]
v_mfma_f32_16x16x32_bf16 v[28:31], v[252:255], v[180:183], v[28:31]
ds_read_b128 v[240:243], v12 offset:512
ds_read_b128 v[244:247], v12 offset:3584
s_waitcnt lgkmcnt(8)
v_mfma_f32_16x16x32_bf16 v[24:27], v[208:211], v[184:187], v[24:27]
v_mfma_f32_16x16x32_bf16 v[28:31], v[212:215], v[184:187], v[28:31]
ds_read_b128 v[248:251], v13 offset:512
ds_read_b128 v[252:255], v13 offset:3584
s_waitcnt lgkmcnt(8)
v_mfma_f32_16x16x32_bf16 v[24:27], v[216:219], v[188:191], v[24:27]
v_mfma_f32_16x16x32_bf16 v[28:31], v[220:223], v[188:191], v[28:31]
ds_read_b128 v[208:211], v10 offset:24576
ds_read_b128 v[212:215], v10 offset:27648
s_waitcnt lgkmcnt(8)
v_mfma_f32_16x16x32_bf16 v[24:27], v[224:227], v[192:195], v[24:27]
v_mfma_f32_16x16x32_bf16 v[28:31], v[228:231], v[192:195], v[28:31]
ds_read_b128 v[216:219], v11 offset:24576
ds_read_b128 v[220:223], v11 offset:27648
s_waitcnt lgkmcnt(8)
v_mfma_f32_16x16x32_bf16 v[24:27], v[232:235], v[196:199], v[24:27]
v_mfma_f32_16x16x32_bf16 v[28:31], v[236:239], v[196:199], v[28:31]
ds_read_b128 v[224:227], v12 offset:24576
ds_read_b128 v[228:231], v12 offset:27648
s_waitcnt lgkmcnt(8)
v_mfma_f32_16x16x32_bf16 v[24:27], v[240:243], v[200:203], v[24:27]
v_mfma_f32_16x16x32_bf16 v[28:31], v[244:247], v[200:203], v[28:31]
ds_read_b128 v[232:235], v13 offset:24576
ds_read_b128 v[236:239], v13 offset:27648
s_waitcnt lgkmcnt(8)
v_mfma_f32_16x16x32_bf16 v[24:27], v[248:251], v[204:207], v[24:27]
v_mfma_f32_16x16x32_bf16 v[28:31], v[252:255], v[204:207], v[28:31]
ds_read_b128 v[240:243], v10 offset:24832
ds_read_b128 v[244:247], v10 offset:27904
s_waitcnt lgkmcnt(8)
v_mfma_f32_16x16x32_bf16 v[32:35], v[208:211], v[160:163], 0
v_mfma_f32_16x16x32_bf16 v[36:39], v[212:215], v[160:163], 0
ds_read_b128 v[248:251], v11 offset:24832
ds_read_b128 v[252:255], v11 offset:27904
s_waitcnt lgkmcnt(8)
v_mfma_f32_16x16x32_bf16 v[32:35], v[216:219], v[164:167], v[32:35]
v_mfma_f32_16x16x32_bf16 v[36:39], v[220:223], v[164:167], v[36:39]
ds_read_b128 v[208:211], v12 offset:24832
ds_read_b128 v[212:215], v12 offset:27904
s_waitcnt lgkmcnt(8)
v_mfma_f32_16x16x32_bf16 v[32:35], v[224:227], v[168:171], v[32:35]
v_mfma_f32_16x16x32_bf16 v[36:39], v[228:231], v[168:171], v[36:39]
ds_read_b128 v[216:219], v13 offset:24832
ds_read_b128 v[220:223], v13 offset:27904
s_waitcnt lgkmcnt(8)
v_mfma_f32_16x16x32_bf16 v[32:35], v[232:235], v[172:175], v[32:35]
v_mfma_f32_16x16x32_bf16 v[36:39], v[236:239], v[172:175], v[36:39]
ds_read_b128 v[224:227], v10 offset:25088
ds_read_b128 v[228:231], v10 offset:28160
v_cvt_pk_bf16_f32 v100, v24, v25
v_cvt_pk_bf16_f32 v101, v26, v27
v_cvt_pk_bf16_f32 v102, v28, v29
v_cvt_pk_bf16_f32 v103, v30, v31
s_waitcnt lgkmcnt(8)
v_mfma_f32_16x16x32_bf16 v[32:35], v[240:243], v[176:179], v[32:35]
v_mfma_f32_16x16x32_bf16 v[36:39], v[244:247], v[176:179], v[36:39]
ds_read_b128 v[232:235], v11 offset:25088
ds_read_b128 v[236:239], v11 offset:28160
s_waitcnt lgkmcnt(8)
v_mfma_f32_16x16x32_bf16 v[32:35], v[248:251], v[180:183], v[32:35]
v_mfma_f32_16x16x32_bf16 v[36:39], v[252:255], v[180:183], v[36:39]
ds_read_b128 v[240:243], v12 offset:25088
ds_read_b128 v[244:247], v12 offset:28160
s_waitcnt lgkmcnt(8)
v_mfma_f32_16x16x32_bf16 v[32:35], v[208:211], v[184:187], v[32:35]
v_mfma_f32_16x16x32_bf16 v[36:39], v[212:215], v[184:187], v[36:39]
ds_read_b128 v[248:251], v13 offset:25088
ds_read_b128 v[252:255], v13 offset:28160
s_waitcnt lgkmcnt(8)
v_mfma_f32_16x16x32_bf16 v[32:35], v[216:219], v[188:191], v[32:35]
v_mfma_f32_16x16x32_bf16 v[36:39], v[220:223], v[188:191], v[36:39]
ds_read_b128 v[208:211], v10 offset:49152
ds_read_b128 v[212:215], v10 offset:52224
s_waitcnt lgkmcnt(8)
v_mfma_f32_16x16x32_bf16 v[32:35], v[224:227], v[192:195], v[32:35]
v_mfma_f32_16x16x32_bf16 v[36:39], v[228:231], v[192:195], v[36:39]
ds_read_b128 v[216:219], v11 offset:49152
ds_read_b128 v[220:223], v11 offset:52224
s_waitcnt lgkmcnt(8)
v_mfma_f32_16x16x32_bf16 v[32:35], v[232:235], v[196:199], v[32:35]
v_mfma_f32_16x16x32_bf16 v[36:39], v[236:239], v[196:199], v[36:39]
ds_read_b128 v[224:227], v12 offset:49152
ds_read_b128 v[228:231], v12 offset:52224
s_waitcnt lgkmcnt(8)
v_mfma_f32_16x16x32_bf16 v[32:35], v[240:243], v[200:203], v[32:35]
v_mfma_f32_16x16x32_bf16 v[36:39], v[244:247], v[200:203], v[36:39]
ds_read_b128 v[232:235], v13 offset:49152
ds_read_b128 v[236:239], v13 offset:52224
s_waitcnt lgkmcnt(8)
v_mfma_f32_16x16x32_bf16 v[32:35], v[248:251], v[204:207], v[32:35]
v_mfma_f32_16x16x32_bf16 v[36:39], v[252:255], v[204:207], v[36:39]
ds_read_b128 v[240:243], v10 offset:49408
ds_read_b128 v[244:247], v10 offset:52480
s_waitcnt lgkmcnt(8)
v_mfma_f32_16x16x32_bf16 v[24:27], v[208:211], v[160:163], 0
v_mfma_f32_16x16x32_bf16 v[28:31], v[212:215], v[160:163], 0
ds_read_b128 v[248:251], v11 offset:49408
ds_read_b128 v[252:255], v11 offset:52480
s_waitcnt lgkmcnt(8)
v_mfma_f32_16x16x32_bf16 v[24:27], v[216:219], v[164:167], v[24:27]
v_mfma_f32_16x16x32_bf16 v[28:31], v[220:223], v[164:167], v[28:31]
ds_read_b128 v[208:211], v12 offset:49408
ds_read_b128 v[212:215], v12 offset:52480
s_waitcnt lgkmcnt(8)
v_mfma_f32_16x16x32_bf16 v[24:27], v[224:227], v[168:171], v[24:27]
v_mfma_f32_16x16x32_bf16 v[28:31], v[228:231], v[168:171], v[28:31]
ds_read_b128 v[216:219], v13 offset:49408
ds_read_b128 v[220:223], v13 offset:52480
s_waitcnt lgkmcnt(8)
v_mfma_f32_16x16x32_bf16 v[24:27], v[232:235], v[172:175], v[24:27]
v_mfma_f32_16x16x32_bf16 v[28:31], v[236:239], v[172:175], v[28:31]
ds_read_b128 v[224:227], v10 offset:49664
ds_read_b128 v[228:231], v10 offset:52736
v_cvt_pk_bf16_f32 v104, v32, v33
v_cvt_pk_bf16_f32 v105, v34, v35
v_cvt_pk_bf16_f32 v106, v36, v37
v_cvt_pk_bf16_f32 v107, v38, v39
s_waitcnt lgkmcnt(8)
v_mfma_f32_16x16x32_bf16 v[24:27], v[240:243], v[176:179], v[24:27]
v_mfma_f32_16x16x32_bf16 v[28:31], v[244:247], v[176:179], v[28:31]
ds_read_b128 v[232:235], v11 offset:49664
ds_read_b128 v[236:239], v11 offset:52736
s_waitcnt lgkmcnt(8)
v_mfma_f32_16x16x32_bf16 v[24:27], v[248:251], v[180:183], v[24:27]
v_mfma_f32_16x16x32_bf16 v[28:31], v[252:255], v[180:183], v[28:31]
ds_read_b128 v[240:243], v12 offset:49664
ds_read_b128 v[244:247], v12 offset:52736
s_waitcnt lgkmcnt(8)
v_mfma_f32_16x16x32_bf16 v[24:27], v[208:211], v[184:187], v[24:27]
v_mfma_f32_16x16x32_bf16 v[28:31], v[212:215], v[184:187], v[28:31]
ds_read_b128 v[248:251], v13 offset:49664
ds_read_b128 v[252:255], v13 offset:52736
s_waitcnt lgkmcnt(8)
v_mfma_f32_16x16x32_bf16 v[24:27], v[216:219], v[188:191], v[24:27]
v_mfma_f32_16x16x32_bf16 v[28:31], v[220:223], v[188:191], v[28:31]
s_waitcnt lgkmcnt(6)
v_mfma_f32_16x16x32_bf16 v[24:27], v[224:227], v[192:195], v[24:27]
v_mfma_f32_16x16x32_bf16 v[28:31], v[228:231], v[192:195], v[28:31]
s_waitcnt lgkmcnt(4)
v_mfma_f32_16x16x32_bf16 v[24:27], v[232:235], v[196:199], v[24:27]
v_mfma_f32_16x16x32_bf16 v[28:31], v[236:239], v[196:199], v[28:31]
s_waitcnt lgkmcnt(2)
v_mfma_f32_16x16x32_bf16 v[24:27], v[240:243], v[200:203], v[24:27]
v_mfma_f32_16x16x32_bf16 v[28:31], v[244:247], v[200:203], v[28:31]
s_waitcnt lgkmcnt(0)
v_mfma_f32_16x16x32_bf16 v[24:27], v[248:251], v[204:207], v[24:27]
v_mfma_f32_16x16x32_bf16 v[28:31], v[252:255], v[204:207], v[28:31]
s_nop 7
v_cvt_pk_bf16_f32 v108, v24, v25
v_cvt_pk_bf16_f32 v109, v26, v27
v_cvt_pk_bf16_f32 v110, v28, v29
v_cvt_pk_bf16_f32 v111, v30, v31
s_sub_u32 s41, s41, 1
s_cmp_lg_u32 s41, 0
s_cbranch_scc1 H_wr
s_waitcnt vmcnt(0)
H_nowov:
s_and_b32 s38, s36, 3
s_mul_i32 s38, s38, 12
s_add_u32 s38, s38, s3
s_barrier
s_mul_i32 s39, s37, 147456
s_mov_b32 s40, 6
H_w2l:
s_cmp_ge_u32 s38, 48
s_cselect_b32 s6, 48, 0
s_sub_u32 s38, s38, s6
s_mul_i32 s7, s38, 3072
s_add_u32 s6, s7, s39
s_mov_b32 m0, s7
s_add_u32 s38, s38, 8
buffer_load_dwordx4 v14, s[16:19], s6 offen offset:0 lds
buffer_load_dwordx4 v15, s[16:19], s6 offen offset:1024 lds
buffer_load_dwordx4 v16, s[16:19], s6 offen offset:2048 lds
s_sub_u32 s40, s40, 1
s_cmp_lg_u32 s40, 0
s_cbranch_scc1 H_w2l
s_waitcnt vmcnt(0)
s_barrier
s_cmp_lt_u32 s3, 4
s_cbranch_scc1 H_m1
s_sub_u32 s38, s3, 4
v_lshrrev_b32 v4, 2, v1
v_lshl_add_u32 v6, v2, 3, v4
v_mul_u32_u24 v6, 768, v6
v_and_b32 v5, 3, v1
v_lshl_add_u32 v6, v5, 3, v6
v_and_b32 v5, 1, v2
v_lshl_add_u32 v4, v5, 2, v4
s_mul_i32 s6, s38, 6
v_xor_b32 v5, s6, v4
v_lshl_add_u32 v32, v5, 5, v6
s_add_u32 s6, s6, 1
v_xor_b32 v5, s6, v4
v_lshl_add_u32 v33, v5, 5, v6
s_add_u32 s6, s6, 1
v_xor_b32 v5, s6, v4
v_lshl_add_u32 v34, v5, 5, v6
s_add_u32 s6, s6, 1
v_xor_b32 v5, s6, v4
v_lshl_add_u32 v35, v5, 5, v6
s_add_u32 s6, s6, 1
v_xor_b32 v5, s6, v4
v_lshl_add_u32 v36, v5, 5, v6
s_add_u32 s6, s6, 1
v_xor_b32 v5, s6, v4
v_lshl_add_u32 v37, v5, 5, v6
s_add_u32 s6, s6, 1
ds_read_b64_tr_b16 v[112:113], v32 offset:0
ds_read_b64_tr_b16 v[114:115], v32 offset:3072
ds_read_b64_tr_b16 v[136:137], v33 offset:0
ds_read_b64_tr_b16 v[138:139], v33 offset:3072
ds_read_b64_tr_b16 v[160:161], v34 offset:0
ds_read_b64_tr_b16 v[162:163], v34 offset:3072
s_waitcnt lgkmcnt(6)
ds_read_b64_tr_b16 v[184:185], v35 offset:0
ds_read_b64_tr_b16 v[186:187], v35 offset:3072
ds_read_b64_tr_b16 v[208:209], v36 offset:0
ds_read_b64_tr_b16 v[210:211], v36 offset:3072
ds_read_b64_tr_b16 v[232:233], v37 offset:0
ds_read_b64_tr_b16 v[234:235], v37 offset:3072
s_waitcnt lgkmcnt(6)
ds_read_b64_tr_b16 v[116:117], v32 offset:24576
ds_read_b64_tr_b16 v[118:119], v32 offset:27648
ds_read_b64_tr_b16 v[140:141], v33 offset:24576
ds_read_b64_tr_b16 v[142:143], v33 offset:27648
ds_read_b64_tr_b16 v[164:165], v34 offset:24576
ds_read_b64_tr_b16 v[166:167], v34 offset:27648
s_waitcnt lgkmcnt(6)
ds_read_b64_tr_b16 v[188:189], v35 offset:24576
ds_read_b64_tr_b16 v[190:191], v35 offset:27648
ds_read_b64_tr_b16 v[212:213], v36 offset:24576
ds_read_b64_tr_b16 v[214:215], v36 offset:27648
ds_read_b64_tr_b16 v[236:237], v37 offset:24576
ds_read_b64_tr_b16 v[238:239], v37 offset:27648
s_waitcnt lgkmcnt(6)
v_add_u32 v32, 49152, v32
ds_read_b64_tr_b16 v[120:121], v32 offset:0
ds_read_b64_tr_b16 v[122:123], v32 offset:3072
v_add_u32 v33, 49152, v33
ds_read_b64_tr_b16 v[144:145], v33 offset:0
ds_read_b64_tr_b16 v[146:147], v33 offset:3072
v_add_u32 v34, 49152, v34
ds_read_b64_tr_b16 v[168:169], v34 offset:0
ds_read_b64_tr_b16 v[170:171], v34 offset:3072
s_waitcnt lgkmcnt(6)
v_add_u32 v35, 49152, v35
ds_read_b64_tr_b16 v[192:193], v35 offset:0
ds_read_b64_tr_b16 v[194:195], v35 offset:3072
v_add_u32 v36, 49152, v36
ds_read_b64_tr_b16 v[216:217], v36 offset:0
ds_read_b64_tr_b16 v[218:219], v36 offset:3072
v_add_u32 v37, 49152, v37
ds_read_b64_tr_b16 v[240:241], v37 offset:0
ds_read_b64_tr_b16 v[242:243], v37 offset:3072
s_waitcnt lgkmcnt(6)
ds_read_b64_tr_b16 v[124:125], v32 offset:24576
ds_read_b64_tr_b16 v[126:127], v32 offset:27648
ds_read_b64_tr_b16 v[148:149], v33 offset:24576
ds_read_b64_tr_b16 v[150:151], v33 offset:27648
ds_read_b64_tr_b16 v[172:173], v34 offset:24576
ds_read_b64_tr_b16 v[174:175], v34 offset:27648
s_waitcnt lgkmcnt(6)
ds_read_b64_tr_b16 v[196:197], v35 offset:24576
ds_read_b64_tr_b16 v[198:199], v35 offset:27648
ds_read_b64_tr_b16 v[220:221], v36 offset:24576
ds_read_b64_tr_b16 v[222:223], v36 offset:27648
ds_read_b64_tr_b16 v[244:245], v37 offset:24576
ds_read_b64_tr_b16 v[246:247], v37 offset:27648
s_waitcnt lgkmcnt(6)
v_add_u32 v32, 49152, v32
ds_read_b64_tr_b16 v[128:129], v32 offset:0
ds_read_b64_tr_b16 v[130:131], v32 offset:3072
v_add_u32 v33, 49152, v33
ds_read_b64_tr_b16 v[152:153], v33 offset:0
ds_read_b64_tr_b16 v[154:155], v33 offset:3072
v_add_u32 v34, 49152, v34
ds_read_b64_tr_b16 v[176:177], v34 offset:0
ds_read_b64_tr_b16 v[178:179], v34 offset:3072
s_waitcnt lgkmcnt(6)
v_add_u32 v35, 49152, v35
ds_read_b64_tr_b16 v[200:201], v35 offset:0
ds_read_b64_tr_b16 v[202:203], v35 offset:3072
v_add_u32 v36, 49152, v36
ds_read_b64_tr_b16 v[224:225], v36 offset:0
ds_read_b64_tr_b16 v[226:227], v36 offset:3072
v_add_u32 v37, 49152, v37
ds_read_b64_tr_b16 v[248:249], v37 offset:0
ds_read_b64_tr_b16 v[250:251], v37 offset:3072
s_waitcnt lgkmcnt(6)
ds_read_b64_tr_b16 v[132:133], v32 offset:24576
ds_read_b64_tr_b16 v[134:135], v32 offset:27648
ds_read_b64_tr_b16 v[156:157], v33 offset:24576
ds_read_b64_tr_b16 v[158:159], v33 offset:27648
ds_read_b64_tr_b16 v[180:181], v34 offset:24576
ds_read_b64_tr_b16 v[182:183], v34 offset:27648
s_waitcnt lgkmcnt(6)
ds_read_b64_tr_b16 v[204:205], v35 offset:24576
ds_read_b64_tr_b16 v[206:207], v35 offset:27648
ds_read_b64_tr_b16 v[228:229], v36 offset:24576
ds_read_b64_tr_b16 v[230:231], v36 offset:27648
ds_read_b64_tr_b16 v[252:253], v37 offset:24576
ds_read_b64_tr_b16 v[254:255], v37 offset:27648
s_waitcnt lgkmcnt(6)
s_lshl_b32 s26, s86, 10
s_add_u32 s26, s26, 120832
s_mov_b32 s30, 2097152
W13:
buffer_load_dwordx2 v[6:7], off, s[32:35], s26 sc1
s_waitcnt vmcnt(0)
v_readfirstlane_b32 s28, v6
v_readfirstlane_b32 s29, v7
s_nop 0
s_add_u32 s6, s28, 1
s_addc_u32 s7, s29, 0
s_add_u32 s24, s6, s7
s_mul_i32 s24, s24, 0x01010101
s_lshr_b32 s24, s24, 24
s_cmp_eq_u32 s24, 96
s_cbranch_scc1 W13x
s_sleep 32
s_sub_u32 s30, s30, 1
s_cbranch_scc0 W13
W13x:
s_getreg_b32 s24, hwreg(HW_REG_XCC_ID, 0, 3)
s_lshl_b32 s24, s24, 3
s_lshr_b64 s[6:7], s[6:7], s24
s_and_b32 s6, s6, 0x3f
s_cmp_eq_u32 s6, 32
s_cselect_b32 s45, 2, 1
v_and_b32 v4, 3, v1
v_mul_u32_u24 v4, 896, v4
v_lshrrev_b32 v5, 3, v1
v_lshl_add_u32 v4, v5, 6, v4
v_bfe_u32 v5, v1, 2, 1
v_lshl_add_u32 v4, v5, 7, v4
v_lshl_add_u32 v4, v2, 4, v4
v_mul_u32_u24 v5, 896, v1
v_lshl_add_u32 v5, v2, 3, v5
v_mul_u32_u24 v0, 6144, v2
v_lshl_add_u32 v0, v1, 2, v0
s_mul_i32 s40, s2, 5376
s_add_u32 s40, s40, 2170880
s_add_u32 s41, s40, 3584
s_lshl_b32 s6, s36, 5
s_add_u32 s6, s6, s37
s_mul_i32 s42, s6, 768
s_mul_i32 s6, s38, 192
s_add_u32 s42, s42, s6
s_add_u32 s42, s42, 2514944
s_add_u32 s43, s42, 196608
s_mov_b32 s26, 0x3b2aaaab
v_mov_b32 v6, 0xff800000
v_mov_b32 v7, 0
v_mov_b32 v20, 0
v_mov_b32 v21, 0
v_mov_b32 v22, 0
v_mov_b32 v23, 0
v_mov_b32 v24, 0
v_mov_b32 v25, 0
v_mov_b32 v26, 0
v_mov_b32 v27, 0
v_mov_b32 v28, 0
v_mov_b32 v29, 0
v_mov_b32 v30, 0
v_mov_b32 v31, 0
s_waitcnt lgkmcnt(0)
s_barrier
s_mov_b32 s30, 2097152
s_mov_b32 exec_lo, 0x003f003f
s_mov_b32 exec_hi, 0x003f003f
s_branch X_g1
X_gate:
buffer_load_dwordx2 v[6:7], v5, s[32:35], s40 offen offset:768 sc1
s_sub_u32 s30, s30, 1
s_cbranch_scc1 X_g1
s_waitcnt vmcnt(0)
v_cmp_ne_u32 vcc, -1, v6
s_cbranch_vccnz X_g1
s_sleep 1
s_branch X_gate
X_g1:
s_mov_b32 s30, 2097152
s_branch X_poll
X_poll0:
s_sleep 2
X_poll:
s_mov_b32 exec_lo, 0x003f003f
s_mov_b32 exec_hi, 0x003f003f
buffer_load_dwordx2 v[6:7], v5, s[32:35], s40 offen offset:768 sc1
s_mov_b32 exec_lo, 0x33333333
s_mov_b32 exec_hi, 0x33333333
buffer_load_dwordx4 v[20:23], v4, s[32:35], s41 offen offset:0 sc1
buffer_load_dwordx4 v[24:27], v4, s[32:35], s41 offen offset:256 sc1
buffer_load_dwordx4 v[28:31], v4, s[32:35], s41 offen offset:512 sc1
s_mov_b64 exec, -1
buffer_load_dwordx4 v[8:11], v4, s[32:35], s40 offen offset:0 sc1
buffer_load_dwordx4 v[12:15], v4, s[32:35], s40 offen offset:256 sc1
buffer_load_dwordx4 v[16:19], v4, s[32:35], s40 offen offset:512 sc1
s_sub_u32 s30, s30, 1
s_cselect_b64 s[48:49], 0, -1
s_waitcnt vmcnt(3)
v_max3_u32 v2, v6, v7, v20
v_max3_u32 v2, v2, v21, v22
v_max3_u32 v2, v2, v23, v24
v_max3_u32 v2, v2, v25, v26
v_max3_u32 v2, v2, v27, v28
v_max3_u32 v2, v2, v29, v30
v_max_u32 v2, v2, v31
v_mfma_f32_16x16x32_bf16 v[36:39], v[20:23], v[40:43], 0
v_mfma_f32_16x16x32_bf16 v[36:39], v[24:27], v[44:47], v[36:39]
v_mfma_f32_16x16x32_bf16 v[36:39], v[28:31], v[48:51], v[36:39]
s_waitcnt vmcnt(0)
v_mfma_f32_16x16x32_bf16 v[32:35], v[8:11], v[40:43], 0
v_max3_u32 v2, v2, v8, v9
v_max3_u32 v2, v2, v10, v11
v_mfma_f32_16x16x32_bf16 v[32:35], v[12:15], v[44:47], v[32:35]
v_max3_u32 v2, v2, v12, v13
v_max3_u32 v2, v2, v14, v15
v_mfma_f32_16x16x32_bf16 v[32:35], v[16:19], v[48:51], v[32:35]
v_max3_u32 v2, v2, v16, v17
v_max3_u32 v2, v2, v18, v19
v_cmp_eq_u32 vcc, -1, v2
s_and_b64 vcc, vcc, s[48:49]
s_cbranch_scc1 X_poll0
v_mfma_f32_16x16x32_bf16 v[40:43], v[8:11], v[52:55], 0
v_mov_b32 v4, v6
s_nop 0
v_mfma_f32_16x16x32_bf16 v[40:43], v[12:15], v[56:59], v[40:43]
v_max_f32_dpp v4, v4, v4 row_ror:8 row_mask:0xf bank_mask:0xf
s_nop 0
v_mfma_f32_16x16x32_bf16 v[40:43], v[16:19], v[60:63], v[40:43]
v_max_f32_dpp v4, v4, v4 row_ror:4 row_mask:0xf bank_mask:0xf
s_nop 0
v_mfma_f32_16x16x32_bf16 v[44:47], v[20:23], v[52:55], 0
v_max_f32_dpp v4, v4, v4 row_ror:2 row_mask:0xf bank_mask:0xf
s_nop 0
v_mfma_f32_16x16x32_bf16 v[44:47], v[24:27], v[56:59], v[44:47]
v_max_f32_dpp v4, v4, v4 row_ror:1 row_mask:0xf bank_mask:0xf
s_nop 0
v_mfma_f32_16x16x32_bf16 v[44:47], v[28:31], v[60:63], v[44:47]
v_sub_f32 v6, v6, v4
v_exp_f32 v6, v6
v_mfma_f32_16x16x32_bf16 v[52:55], v[8:11], v[64:67], 0
s_nop 0
v_mul_f32 v7, v7, v6
v_mfma_f32_16x16x32_bf16 v[52:55], v[12:15], v[68:71], v[52:55]
s_nop 0
s_nop 0
v_mfma_f32_16x16x32_bf16 v[52:55], v[16:19], v[72:75], v[52:55]
v_add_f32_dpp v7, v7, v7 row_ror:8 row_mask:0xf bank_mask:0xf
s_nop 0
v_mfma_f32_16x16x32_bf16 v[56:59], v[20:23], v[64:67], 0
v_add_f32_dpp v7, v7, v7 row_ror:4 row_mask:0xf bank_mask:0xf
s_nop 0
v_mfma_f32_16x16x32_bf16 v[56:59], v[24:27], v[68:71], v[56:59]
v_add_f32_dpp v7, v7, v7 row_ror:2 row_mask:0xf bank_mask:0xf
s_nop 0
v_mfma_f32_16x16x32_bf16 v[56:59], v[28:31], v[72:75], v[56:59]
v_add_f32_dpp v7, v7, v7 row_ror:1 row_mask:0xf bank_mask:0xf
s_nop 0
v_mfma_f32_16x16x32_bf16 v[64:67], v[8:11], v[76:79], 0
v_rcp_f32 v7, v7
s_nop 0
v_mfma_f32_16x16x32_bf16 v[64:67], v[12:15], v[80:83], v[64:67]
v_mul_f32 v6, v6, v7
s_nop 0
v_mfma_f32_16x16x32_bf16 v[64:67], v[16:19], v[84:87], v[64:67]
v_mov_b32_dpp v48, v6 row_newbcast:0 row_mask:0xf bank_mask:0xf
v_mov_b32_dpp v49, v6 row_newbcast:1 row_mask:0xf bank_mask:0xf
v_mfma_f32_16x16x32_bf16 v[68:71], v[20:23], v[76:79], 0
v_mov_b32_dpp v50, v6 row_newbcast:2 row_mask:0xf bank_mask:0xf
v_mov_b32_dpp v51, v6 row_newbcast:3 row_mask:0xf bank_mask:0xf
v_mfma_f32_16x16x32_bf16 v[68:71], v[24:27], v[80:83], v[68:71]
v_mov_b32_dpp v60, v6 row_newbcast:4 row_mask:0xf bank_mask:0xf
v_mov_b32_dpp v61, v6 row_newbcast:5 row_mask:0xf bank_mask:0xf
v_mfma_f32_16x16x32_bf16 v[68:71], v[28:31], v[84:87], v[68:71]
v_mul_f32 v32, v48, v32
v_fmac_f32 v32, v49, v33
v_mfma_f32_16x16x32_bf16 v[76:79], v[8:11], v[88:91], 0
v_fmac_f32 v32, v50, v34
v_fmac_f32 v32, v51, v35
v_mfma_f32_16x16x32_bf16 v[76:79], v[12:15], v[92:95], v[76:79]
v_fmac_f32 v32, v60, v36
v_fmac_f32 v32, v61, v37
v_mfma_f32_16x16x32_bf16 v[76:79], v[16:19], v[96:99], v[76:79]
v_mul_f32 v40, v48, v40
v_fmac_f32 v40, v49, v41
v_mfma_f32_16x16x32_bf16 v[80:83], v[20:23], v[88:91], 0
v_fmac_f32 v40, v50, v42
v_fmac_f32 v40, v51, v43
v_mfma_f32_16x16x32_bf16 v[80:83], v[24:27], v[92:95], v[80:83]
v_fmac_f32 v40, v60, v44
v_fmac_f32 v40, v61, v45
v_mfma_f32_16x16x32_bf16 v[80:83], v[28:31], v[96:99], v[80:83]
v_mul_f32 v52, v48, v52
v_fmac_f32 v52, v49, v53
v_mfma_f32_16x16x32_bf16 v[88:91], v[8:11], v[100:103], 0
v_fmac_f32 v52, v50, v54
v_fmac_f32 v52, v51, v55
v_mfma_f32_16x16x32_bf16 v[88:91], v[12:15], v[104:107], v[88:91]
v_fmac_f32 v52, v60, v56
v_fmac_f32 v52, v61, v57
v_mfma_f32_16x16x32_bf16 v[88:91], v[16:19], v[108:111], v[88:91]
v_cvt_pk_bf16_f32 v34, v32, v40
v_mul_f32 v64, v48, v64
v_mfma_f32_16x16x32_bf16 v[92:95], v[20:23], v[100:103], 0
v_fmac_f32 v64, v49, v65
v_fmac_f32 v64, v50, v66
v_mfma_f32_16x16x32_bf16 v[92:95], v[24:27], v[104:107], v[92:95]
v_fmac_f32 v64, v51, v67
v_fmac_f32 v64, v60, v68
v_mfma_f32_16x16x32_bf16 v[92:95], v[28:31], v[108:111], v[92:95]
v_fmac_f32 v64, v61, v69
v_cvt_pk_bf16_f32 v35, v52, v64
v_mul_f32 v76, v48, v76
v_fmac_f32 v76, v49, v77
v_fmac_f32 v76, v50, v78
v_fmac_f32 v76, v51, v79
v_fmac_f32 v76, v60, v80
v_fmac_f32 v76, v61, v81
s_nop 1
v_mul_f32 v88, v48, v88
v_fmac_f32 v88, v49, v89
v_fmac_f32 v88, v50, v90
v_fmac_f32 v88, v51, v91
v_fmac_f32 v88, v60, v92
v_fmac_f32 v88, v61, v93
v_cvt_pk_bf16_f32 v36, v76, v88
s_cmp_eq_u32 s45, 2
s_cbranch_scc0 T14g
buffer_store_dword v34, v0, s[32:35], s42 offen offset:0
buffer_store_dword v35, v0, s[32:35], s42 offen offset:64
buffer_store_dword v36, v0, s[32:35], s42 offen offset:128
T14r:
s_barrier
v_lshrrev_b32 v2, 4, v3
v_lshrrev_b32 v4, 2, v1
v_mul_u32_u24 v14, 448, v4
v_lshl_add_u32 v14, v2, 4, v14
v_add_u32 v14, 4096, v14
s_mul_i32 s6, s38, 832
v_lshl_add_u32 v12, v3, 4, s6
s_lshl_b32 s6, s38, 3
s_add_u32 s6, s6, 8192
v_mov_b32 v13, s6
v_mov_b32 v20, 0
v_mov_b32 v21, 0
v_mov_b32 v22, 0
v_mov_b32 v23, 0
s_setprio 2
s_mov_b32 s46, 0
s_mov_b32 s47, 0x80000000
v_mov_b32 v24, 0x3f803f80
s_barrier
s_mov_b32 exec_hi, 0xffff
ds_read_b128 v[20:23], v12
s_mov_b32 exec_hi, -1
s_waitcnt lgkmcnt(0)
v_dot2_f32_bf16 v4, v20, v24, 0
v_dot2_f32_bf16 v5, v20, v20, 0
v_dot2_f32_bf16 v4, v21, v24, v4
v_dot2_f32_bf16 v5, v21, v21, v5
v_dot2_f32_bf16 v4, v22, v24, v4
v_dot2_f32_bf16 v5, v22, v22, v5
v_dot2_f32_bf16 v4, v23, v24, v4
v_dot2_f32_bf16 v5, v23, v23, v5
s_nop 1
s_nop 0
v_add_f32_dpp v4, v4, v4 row_ror:8 row_mask:0xf bank_mask:0xf
v_add_f32_dpp v5, v5, v5 row_ror:8 row_mask:0xf bank_mask:0xf
s_nop 0
v_add_f32_dpp v4, v4, v4 row_ror:4 row_mask:0xf bank_mask:0xf
v_add_f32_dpp v5, v5, v5 row_ror:4 row_mask:0xf bank_mask:0xf
s_nop 0
v_add_f32_dpp v4, v4, v4 row_ror:2 row_mask:0xf bank_mask:0xf
v_add_f32_dpp v5, v5, v5 row_ror:2 row_mask:0xf bank_mask:0xf
s_nop 0
v_add_f32_dpp v4, v4, v4 row_ror:1 row_mask:0xf bank_mask:0xf
v_add_f32_dpp v5, v5, v5 row_ror:1 row_mask:0xf bank_mask:0xf
s_nop 0
v_add_f32_dpp v4, v4, v4 row_bcast:15 row_mask:0xa bank_mask:0xf
v_add_f32_dpp v5, v5, v5 row_bcast:15 row_mask:0xa bank_mask:0xf
s_nop 0
v_add_f32_dpp v4, v4, v4 row_bcast:31 row_mask:0xc bank_mask:0xf
v_add_f32_dpp v5, v5, v5 row_bcast:31 row_mask:0xc bank_mask:0xf
v_mul_f32 v7, s26, v4
v_mul_f32 v6, v7, v7
v_fma_f32 v5, v5, s26, -v6
v_max_f32 v5, 0, v5
v_add_f32 v5, 0x3727c5ac, v5
v_rsq_f32 v6, v5
s_mov_b64 exec, s[46:47]
v_mul_f32 v7, v7, v6
ds_write_b64 v13, v[6:7]
s_mov_b64 exec, -1
s_waitcnt lgkmcnt(0)
s_barrier
s_barrier
ds_read_b128 v[32:35], v14 offset:0
ds_read_b128 v[36:39], v14 offset:64
ds_read_b128 v[40:43], v14 offset:128
ds_read_b128 v[44:47], v14 offset:192
ds_read_b128 v[48:51], v14 offset:256
ds_read_b128 v[52:55], v14 offset:320
s_waitcnt lgkmcnt(5)
v_mfma_f32_16x16x32_bf16 v[64:67], v[32:35], v[112:115], 0
v_mfma_f32_16x16x32_bf16 v[68:71], v[32:35], v[136:139], 0
s_waitcnt lgkmcnt(4)
v_mfma_f32_16x16x32_bf16 v[64:67], v[36:39], v[116:119], v[64:67]
v_mfma_f32_16x16x32_bf16 v[68:71], v[36:39], v[140:143], v[68:71]
s_waitcnt lgkmcnt(3)
v_mfma_f32_16x16x32_bf16 v[64:67], v[40:43], v[120:123], v[64:67]
v_mfma_f32_16x16x32_bf16 v[68:71], v[40:43], v[144:147], v[68:71]
s_waitcnt lgkmcnt(2)
v_mfma_f32_16x16x32_bf16 v[64:67], v[44:47], v[124:127], v[64:67]
v_mfma_f32_16x16x32_bf16 v[68:71], v[44:47], v[148:151], v[68:71]
s_waitcnt lgkmcnt(1)
v_mfma_f32_16x16x32_bf16 v[64:67], v[48:51], v[128:131], v[64:67]
v_mfma_f32_16x16x32_bf16 v[68:71], v[48:51], v[152:155], v[68:71]
s_waitcnt lgkmcnt(0)
v_mfma_f32_16x16x32_bf16 v[64:67], v[52:55], v[132:135], v[64:67]
v_mfma_f32_16x16x32_bf16 v[68:71], v[52:55], v[156:159], v[68:71]
v_mfma_f32_16x16x32_bf16 v[72:75], v[32:35], v[160:163], 0
v_mfma_f32_16x16x32_bf16 v[76:79], v[32:35], v[184:187], 0
v_mfma_f32_16x16x32_bf16 v[72:75], v[36:39], v[164:167], v[72:75]
v_mfma_f32_16x16x32_bf16 v[76:79], v[36:39], v[188:191], v[76:79]
v_mfma_f32_16x16x32_bf16 v[72:75], v[40:43], v[168:171], v[72:75]
v_mfma_f32_16x16x32_bf16 v[76:79], v[40:43], v[192:195], v[76:79]
v_mfma_f32_16x16x32_bf16 v[72:75], v[44:47], v[172:175], v[72:75]
v_mfma_f32_16x16x32_bf16 v[76:79], v[44:47], v[196:199], v[76:79]
v_cvt_pk_bf16_f32 v56, v64, v68
s_cmp_eq_u32 s45, 2
s_cbranch_scc0 T15g
buffer_store_dword v56, v0, s[32:35], s43 offen offset:0
T15r:
v_mfma_f32_16x16x32_bf16 v[72:75], v[48:51], v[176:179], v[72:75]
v_mfma_f32_16x16x32_bf16 v[76:79], v[48:51], v[200:203], v[76:79]
v_mfma_f32_16x16x32_bf16 v[72:75], v[52:55], v[180:183], v[72:75]
v_mfma_f32_16x16x32_bf16 v[76:79], v[52:55], v[204:207], v[76:79]
v_mfma_f32_16x16x32_bf16 v[80:83], v[32:35], v[208:211], 0
v_mfma_f32_16x16x32_bf16 v[84:87], v[32:35], v[232:235], 0
v_mfma_f32_16x16x32_bf16 v[80:83], v[36:39], v[212:215], v[80:83]
v_mfma_f32_16x16x32_bf16 v[84:87], v[36:39], v[236:239], v[84:87]
v_mfma_f32_16x16x32_bf16 v[80:83], v[40:43], v[216:219], v[80:83]
v_mfma_f32_16x16x32_bf16 v[84:87], v[40:43], v[240:243], v[84:87]
v_mfma_f32_16x16x32_bf16 v[80:83], v[44:47], v[220:223], v[80:83]
v_mfma_f32_16x16x32_bf16 v[84:87], v[44:47], v[244:247], v[84:87]
v_cvt_pk_bf16_f32 v57, v72, v76
s_cmp_eq_u32 s45, 2
s_cbranch_scc0 T16g
buffer_store_dword v57, v0, s[32:35], s43 offen offset:64
T16r:
v_mfma_f32_16x16x32_bf16 v[80:83], v[48:51], v[224:227], v[80:83]
v_mfma_f32_16x16x32_bf16 v[84:87], v[48:51], v[248:251], v[84:87]
v_mfma_f32_16x16x32_bf16 v[80:83], v[52:55], v[228:231], v[80:83]
v_mfma_f32_16x16x32_bf16 v[84:87], v[52:55], v[252:255], v[84:87]
s_nop 7
v_cvt_pk_bf16_f32 v58, v80, v84
s_cmp_eq_u32 s45, 2
s_cbranch_scc0 T17g
buffer_store_dword v58, v0, s[32:35], s43 offen offset:128
T17r:
s_endpgm
T14g:
buffer_store_dword v34, v0, s[32:35], s42 offen offset:0 sc1
buffer_store_dword v35, v0, s[32:35], s42 offen offset:64 sc1
buffer_store_dword v36, v0, s[32:35], s42 offen offset:128 sc1
s_branch T14r
T15g:
buffer_store_dword v56, v0, s[32:35], s43 offen offset:0 sc1
s_branch T15r
T16g:
buffer_store_dword v57, v0, s[32:35], s43 offen offset:64 sc1
s_branch T16r
T17g:
buffer_store_dword v58, v0, s[32:35], s43 offen offset:128 sc1
s_branch T17r
H_m1:
v_mov_b32 v20, 0x3f803f80
v_mov_b32 v21, 0x3f803f80
v_mov_b32 v22, 0x3f803f80
v_mov_b32 v23, 0x3f803f80
s_lshl_b32 s38, s36, 2
s_add_u32 s38, s38, s3
v_lshrrev_b32 v4, 1, v2
v_lshlrev_b32 v4, 8, v4
v_lshl_add_u32 v4, v1, 4, v4
v_and_b32 v5, 1, v2
v_lshl_add_u32 v4, v5, 3, v4
v_and_b32 v6, 0xff, v4
s_mul_i32 s6, s38, 768
buffer_load_dwordx2 v[48:49], v4, s[8:11], s6 offen
buffer_load_dwordx2 v[50:51], v6, s[8:11], s6 offen offset:512
s_mul_i32 s6, s3, 832
v_add_u32 v12, s6, v4
v_mul_u32_u24 v9, 768, v2
v_lshl_add_u32 v9, v1, 4, v9
v_mfma_f32_16x16x32_bf16 v[64:67], v[20:23], v[112:115], 0
v_mfma_f32_16x16x32_bf16 v[68:71], v[20:23], v[160:163], 0
v_mfma_f32_16x16x32_bf16 v[72:75], v[20:23], v[208:211], 0
v_mfma_f32_16x16x32_bf16 v[64:67], v[20:23], v[116:119], v[64:67]
v_mfma_f32_16x16x32_bf16 v[68:71], v[20:23], v[164:167], v[68:71]
v_mfma_f32_16x16x32_bf16 v[72:75], v[20:23], v[212:215], v[72:75]
v_mfma_f32_16x16x32_bf16 v[64:67], v[20:23], v[120:123], v[64:67]
v_mfma_f32_16x16x32_bf16 v[68:71], v[20:23], v[168:171], v[68:71]
v_mfma_f32_16x16x32_bf16 v[72:75], v[20:23], v[216:219], v[72:75]
v_mfma_f32_16x16x32_bf16 v[64:67], v[20:23], v[124:127], v[64:67]
v_mfma_f32_16x16x32_bf16 v[68:71], v[20:23], v[172:175], v[68:71]
v_mfma_f32_16x16x32_bf16 v[72:75], v[20:23], v[220:223], v[72:75]
v_mfma_f32_16x16x32_bf16 v[64:67], v[20:23], v[128:131], v[64:67]
v_mfma_f32_16x16x32_bf16 v[68:71], v[20:23], v[176:179], v[68:71]
v_mfma_f32_16x16x32_bf16 v[72:75], v[20:23], v[224:227], v[72:75]
v_mfma_f32_16x16x32_bf16 v[64:67], v[20:23], v[132:135], v[64:67]
v_mfma_f32_16x16x32_bf16 v[68:71], v[20:23], v[180:183], v[68:71]
v_mfma_f32_16x16x32_bf16 v[72:75], v[20:23], v[228:231], v[72:75]
v_mfma_f32_16x16x32_bf16 v[64:67], v[20:23], v[136:139], v[64:67]
v_mfma_f32_16x16x32_bf16 v[68:71], v[20:23], v[184:187], v[68:71]
v_mfma_f32_16x16x32_bf16 v[72:75], v[20:23], v[232:235], v[72:75]
v_mfma_f32_16x16x32_bf16 v[64:67], v[20:23], v[140:143], v[64:67]
v_mfma_f32_16x16x32_bf16 v[68:71], v[20:23], v[188:191], v[68:71]
v_mfma_f32_16x16x32_bf16 v[72:75], v[20:23], v[236:239], v[72:75]
v_mfma_f32_16x16x32_bf16 v[64:67], v[20:23], v[144:147], v[64:67]
v_mfma_f32_16x16x32_bf16 v[68:71], v[20:23], v[192:195], v[68:71]
v_mfma_f32_16x16x32_bf16 v[72:75], v[20:23], v[240:243], v[72:75]
v_mfma_f32_16x16x32_bf16 v[64:67], v[20:23], v[148:151], v[64:67]
v_mfma_f32_16x16x32_bf16 v[68:71], v[20:23], v[196:199], v[68:71]
v_mfma_f32_16x16x32_bf16 v[72:75], v[20:23], v[244:247], v[72:75]
v_mfma_f32_16x16x32_bf16 v[64:67], v[20:23], v[152:155], v[64:67]
v_mfma_f32_16x16x32_bf16 v[68:71], v[20:23], v[200:203], v[68:71]
v_mfma_f32_16x16x32_bf16 v[72:75], v[20:23], v[248:251], v[72:75]
v_mfma_f32_16x16x32_bf16 v[64:67], v[20:23], v[156:159], v[64:67]
v_mfma_f32_16x16x32_bf16 v[68:71], v[20:23], v[204:207], v[68:71]
v_mfma_f32_16x16x32_bf16 v[72:75], v[20:23], v[252:255], v[72:75]
v_and_b32 v4, 1, v1
v_lshlrev_b32 v4, 4, v4
v_mov_b32 v5, 0x3f80
v_lshlrev_b32 v5, v4, v5
v_lshrrev_b32 v6, 1, v1
v_cmp_eq_u32 vcc, 0, v6
s_nop 1
v_cndmask_b32 v32, 0, v5, vcc
v_cmp_eq_u32 vcc, 4, v6
s_nop 1
v_cndmask_b32 v36, 0, v5, vcc
v_cmp_eq_u32 vcc, 1, v6
s_nop 1
v_cndmask_b32 v33, 0, v5, vcc
v_cmp_eq_u32 vcc, 5, v6
s_nop 1
v_cndmask_b32 v37, 0, v5, vcc
v_cmp_eq_u32 vcc, 2, v6
s_nop 1
v_cndmask_b32 v34, 0, v5, vcc
v_cmp_eq_u32 vcc, 6, v6
s_nop 1
v_cndmask_b32 v38, 0, v5, vcc
v_cmp_eq_u32 vcc, 3, v6
s_nop 1
v_cndmask_b32 v35, 0, v5, vcc
v_cmp_eq_u32 vcc, 7, v6
s_nop 1
v_cndmask_b32 v39, 0, v5, vcc
v_mov_b32 v16, v64
v_mov_b32 v17, v68
v_mov_b32 v18, v72
v_lshrrev_b32 v4, 2, v1
v_mul_u32_u24 v14, 832, v4
v_lshl_add_u32 v14, v2, 4, v14
v_mul_u32_u24 v15, 448, v2
v_lshl_add_u32 v15, v1, 1, v15
s_mul_i32 s6, s3, 96
s_add_u32 s6, s6, 4096
v_add_u32 v15, s6, v15
v_lshlrev_b32 v13, 3, v2
v_add_u32 v13, 8192, v13
v_mov_b32 v19, 0xc0135761
s_mov_b32 s27, 0xbdd2d3e8
s_mul_i32 s46, s38, 6144
s_add_u32 s46, s46, 2514944
v_lshrrev_b32 v4, 1, v2
v_lshlrev_b32 v105, 8, v4
v_lshrrev_b32 v4, 2, v1
v_lshl_add_u32 v105, v4, 6, v105
v_and_b32 v4, 3, v1
v_lshl_add_u32 v105, v4, 3, v105
v_and_b32 v4, 1, v2
v_lshl_add_u32 v105, v4, 2, v105
s_lshr_b32 s6, s37, 1
s_and_b32 s7, s37, 1
s_lshl_b32 s48, s7, 9
s_mul_i32 s24, s6, 832
s_add_u32 s24, s24, s48
v_add_u32 v104, s24, v105
s_lshl_b32 s42, s36, 2
s_add_u32 s42, s42, s6
s_mul_i32 s43, s42, 6144
s_add_u32 s43, s43, s48
s_add_u32 s43, s43, 2711552
s_lshl_b32 s44, s7, 8
s_sub_u32 s44, s43, s44
s_add_u32 s44, s44, 256
s_mul_i32 s42, s42, 768
s_add_u32 s42, s42, s48
s_sub_u32 s49, s7, 1
s_waitcnt vmcnt(0)
v_lshlrev_b32 v24, 16, v48
v_and_b32 v25, 0xffff0000, v48
v_lshlrev_b32 v26, 16, v49
v_and_b32 v27, 0xffff0000, v49
v_lshlrev_b32 v28, 16, v50
v_and_b32 v29, 0xffff0000, v50
v_lshlrev_b32 v30, 16, v51
v_and_b32 v31, 0xffff0000, v51
s_barrier
buffer_load_dwordx4 v[48:51], v9, s[32:35], s46 offen offset:0 sc1
buffer_load_dwordx4 v[52:55], v9, s[32:35], s46 offen offset:3072 sc1
buffer_load_dwordx4 v[56:59], v9, s[32:35], s46 offen offset:256 sc1
buffer_load_dwordx4 v[60:63], v9, s[32:35], s46 offen offset:3328 sc1
buffer_load_dwordx4 v[64:67], v9, s[32:35], s46 offen offset:512 sc1
buffer_load_dwordx4 v[68:71], v9, s[32:35], s46 offen offset:3584 sc1
s_waitcnt vmcnt(0)
buffer_load_dwordx4 v[48:51], v9, s[32:35], s43 offen offset:0 sc1
buffer_load_dwordx4 v[52:55], v9, s[32:35], s43 offen offset:3072 sc1
buffer_load_dwordx4 v[56:59], v9, s[32:35], s44 offen offset:0 sc1
buffer_load_dwordx4 v[60:63], v9, s[32:35], s44 offen offset:3072 sc1
s_waitcnt vmcnt(0)
s_barrier
s_mov_b32 s30, 2097152
M_poll:
buffer_load_dwordx4 v[48:51], v9, s[32:35], s46 offen offset:0 sc1
buffer_load_dwordx4 v[52:55], v9, s[32:35], s46 offen offset:3072 sc1
buffer_load_dwordx4 v[56:59], v9, s[32:35], s46 offen offset:256 sc1
buffer_load_dwordx4 v[60:63], v9, s[32:35], s46 offen offset:3328 sc1
buffer_load_dwordx4 v[64:67], v9, s[32:35], s46 offen offset:512 sc1
buffer_load_dwordx4 v[68:71], v9, s[32:35], s46 offen offset:3584 sc1
s_waitcnt vmcnt(5)
v_mfma_f32_16x16x32_bf16 v[96:99], v[32:35], v[48:51], v[24:27]
s_waitcnt vmcnt(4)
v_mfma_f32_16x16x32_bf16 v[96:99], v[32:35], v[52:55], v[96:99]
s_waitcnt vmcnt(3)
v_mfma_f32_16x16x32_bf16 v[96:99], v[36:39], v[56:59], v[96:99]
s_waitcnt vmcnt(2)
v_mfma_f32_16x16x32_bf16 v[96:99], v[36:39], v[60:63], v[96:99]
s_waitcnt vmcnt(1)
v_mfma_f32_16x16x32_bf16 v[100:103], v[32:35], v[64:67], v[28:31]
s_waitcnt vmcnt(0)
v_mfma_f32_16x16x32_bf16 v[100:103], v[32:35], v[68:71], v[100:103]
s_nop 5
v_cvt_pk_bf16_f32 v20, v96, v97
v_cvt_pk_bf16_f32 v21, v98, v99
v_cmp_u_f32 vcc, v96, v100
v_cvt_pk_bf16_f32 v22, v100, v101
v_cvt_pk_bf16_f32 v23, v102, v103
s_cbranch_vccnz M_fix
M_ok:
ds_write_b64 v12, v[20:21]
s_mov_b64 exec, 0xffffffff
ds_write_b64 v12, v[22:23] offset:512
s_mov_b64 exec, -1
s_waitcnt lgkmcnt(0)
s_barrier
ds_read_b128 v[48:51], v14 offset:0
ds_read_b128 v[52:55], v14 offset:64
ds_read_b128 v[56:59], v14 offset:128
s_waitcnt lgkmcnt(2)
v_mfma_f32_16x16x32_bf16 v[96:99], v[48:51], v[112:115], 0
ds_read_b128 v[60:63], v14 offset:192
v_mfma_f32_16x16x32_bf16 v[100:103], v[48:51], v[160:163], 0
s_waitcnt lgkmcnt(2)
v_mfma_f32_16x16x32_bf16 v[96:99], v[52:55], v[116:119], v[96:99]
ds_read_b128 v[64:67], v14 offset:256
v_mfma_f32_16x16x32_bf16 v[100:103], v[52:55], v[164:167], v[100:103]
s_waitcnt lgkmcnt(2)
v_mfma_f32_16x16x32_bf16 v[96:99], v[56:59], v[120:123], v[96:99]
ds_read_b128 v[68:71], v14 offset:320
v_mfma_f32_16x16x32_bf16 v[100:103], v[56:59], v[168:171], v[100:103]
s_waitcnt lgkmcnt(2)
v_mfma_f32_16x16x32_bf16 v[96:99], v[60:63], v[124:127], v[96:99]
ds_read_b128 v[72:75], v14 offset:384
v_mfma_f32_16x16x32_bf16 v[100:103], v[60:63], v[172:175], v[100:103]
s_waitcnt lgkmcnt(2)
v_mfma_f32_16x16x32_bf16 v[96:99], v[64:67], v[128:131], v[96:99]
ds_read_b128 v[76:79], v14 offset:448
v_mfma_f32_16x16x32_bf16 v[100:103], v[64:67], v[176:179], v[100:103]
s_waitcnt lgkmcnt(2)
v_mfma_f32_16x16x32_bf16 v[96:99], v[68:71], v[132:135], v[96:99]
ds_read_b128 v[80:83], v14 offset:512
v_mfma_f32_16x16x32_bf16 v[100:103], v[68:71], v[180:183], v[100:103]
s_waitcnt lgkmcnt(2)
v_mfma_f32_16x16x32_bf16 v[96:99], v[72:75], v[136:139], v[96:99]
ds_read_b128 v[84:87], v14 offset:576
v_mfma_f32_16x16x32_bf16 v[100:103], v[72:75], v[184:187], v[100:103]
s_waitcnt lgkmcnt(2)
v_mfma_f32_16x16x32_bf16 v[96:99], v[76:79], v[140:143], v[96:99]
ds_read_b128 v[88:91], v14 offset:640
v_mfma_f32_16x16x32_bf16 v[100:103], v[76:79], v[188:191], v[100:103]
s_waitcnt lgkmcnt(2)
v_mfma_f32_16x16x32_bf16 v[96:99], v[80:83], v[144:147], v[96:99]
ds_read_b128 v[92:95], v14 offset:704
v_mfma_f32_16x16x32_bf16 v[100:103], v[80:83], v[192:195], v[100:103]
s_waitcnt lgkmcnt(2)
v_mfma_f32_16x16x32_bf16 v[96:99], v[84:87], v[148:151], v[96:99]
v_mfma_f32_16x16x32_bf16 v[100:103], v[84:87], v[196:199], v[100:103]
s_waitcnt lgkmcnt(1)
v_mfma_f32_16x16x32_bf16 v[96:99], v[88:91], v[152:155], v[96:99]
v_mfma_f32_16x16x32_bf16 v[100:103], v[88:91], v[200:203], v[100:103]
s_waitcnt lgkmcnt(0)
v_mfma_f32_16x16x32_bf16 v[96:99], v[92:95], v[156:159], v[96:99]
v_mfma_f32_16x16x32_bf16 v[100:103], v[92:95], v[204:207], v[100:103]
s_barrier
ds_read_b64 v[4:5], v13
v_mfma_f32_16x16x32_bf16 v[108:111], v[48:51], v[208:211], 0
v_mfma_f32_16x16x32_bf16 v[108:111], v[52:55], v[212:215], v[108:111]
v_mfma_f32_16x16x32_bf16 v[108:111], v[56:59], v[216:219], v[108:111]
s_waitcnt lgkmcnt(0)
v_mul_f32 v20, v5, v16
v_mul_f32 v21, v5, v17
v_mfma_f32_16x16x32_bf16 v[108:111], v[60:63], v[220:223], v[108:111]
v_mul_f32 v22, v5, v18
s_nop 0
v_mfma_f32_16x16x32_bf16 v[108:111], v[64:67], v[224:227], v[108:111]
v_fma_f32 v20, v96, v4, -v20
v_fma_f32 v21, v100, v4, -v21
v_mfma_f32_16x16x32_bf16 v[108:111], v[68:71], v[228:231], v[108:111]
v_mul_f32 v6, v20, v20
v_mul_f32 v7, v21, v21
v_mfma_f32_16x16x32_bf16 v[108:111], v[72:75], v[232:235], v[108:111]
v_fma_f32 v6, v6, s27, v19
v_fma_f32 v7, v7, s27, v19
v_mfma_f32_16x16x32_bf16 v[108:111], v[76:79], v[236:239], v[108:111]
v_mul_f32 v6, v6, v20
v_mul_f32 v7, v7, v21
v_mfma_f32_16x16x32_bf16 v[108:111], v[80:83], v[240:243], v[108:111]
v_exp_f32 v6, v6
v_exp_f32 v7, v7
v_mfma_f32_16x16x32_bf16 v[108:111], v[84:87], v[244:247], v[108:111]
v_add_f32 v6, 1.0, v6
v_add_f32 v7, 1.0, v7
v_mfma_f32_16x16x32_bf16 v[108:111], v[88:91], v[248:251], v[108:111]
v_rcp_f32 v6, v6
v_rcp_f32 v7, v7
v_mfma_f32_16x16x32_bf16 v[108:111], v[92:95], v[252:255], v[108:111]
v_mul_f32 v20, v20, v6
v_mul_f32 v21, v21, v7
v_cvt_pk_bf16_f32 v20, v20, v21
s_nop 1
ds_write_b16 v15, v20
ds_write_b16_d16_hi v15, v20 offset:32
s_nop 0
v_fma_f32 v22, v108, v4, -v22
v_mul_f32 v10, v22, v22
v_fma_f32 v10, v10, s27, v19
v_mul_f32 v10, v10, v22
v_exp_f32 v10, v10
s_nop 0
v_add_f32 v10, 1.0, v10
v_rcp_f32 v10, v10
s_nop 0
v_mul_f32 v22, v22, v10
v_cvt_pk_bf16_f32 v22, v22, v22
ds_write_b16 v15, v22 offset:64
s_waitcnt lgkmcnt(0)
s_barrier
s_cmp_lg_u32 s3, 0
s_cbranch_scc1 K_done
s_mov_b32 exec_hi, s49
ds_read2_b32 v[20:21], v104 offset0:0 offset1:8
s_mov_b32 exec_hi, -1
s_mov_b32 s30, 2097152
s_waitcnt lgkmcnt(0)
v_lshlrev_b32 v24, 16, v20
v_lshlrev_b32 v25, 16, v21
v_and_b32 v26, 0xffff0000, v20
v_and_b32 v27, 0xffff0000, v21
F_poll:
buffer_load_dwordx4 v[48:51], v9, s[32:35], s43 offen offset:0 sc1
buffer_load_dwordx4 v[52:55], v9, s[32:35], s43 offen offset:3072 sc1
buffer_load_dwordx4 v[56:59], v9, s[32:35], s44 offen offset:0 sc1
buffer_load_dwordx4 v[60:63], v9, s[32:35], s44 offen offset:3072 sc1
s_waitcnt vmcnt(3)
v_mfma_f32_16x16x32_bf16 v[96:99], v[32:35], v[48:51], v[24:27]
s_waitcnt vmcnt(2)
v_mfma_f32_16x16x32_bf16 v[96:99], v[32:35], v[52:55], v[96:99]
s_waitcnt vmcnt(1)
v_mfma_f32_16x16x32_bf16 v[96:99], v[36:39], v[56:59], v[96:99]
s_waitcnt vmcnt(0)
v_mfma_f32_16x16x32_bf16 v[96:99], v[36:39], v[60:63], v[96:99]
s_nop 6
s_mov_b32 exec_hi, s49
v_cmp_u_f32 vcc, v96, v96
v_cvt_pk_bf16_f32 v4, v96, v98
v_cvt_pk_bf16_f32 v5, v97, v99
s_cbranch_vccnz F_fix
F_ok:
buffer_store_dword v4, v105, s[20:23], s42 offen
buffer_store_dword v5, v105, s[20:23], s42 offen offset:32
s_endpgm
M_fix:
s_sub_u32 s30, s30, 1
s_cbranch_scc1 M_ok
s_and_b32 s25, s30, 63
s_cbranch_scc1 M_poll
v_max3_u32 v4, v48, v49, v50
v_max3_u32 v4, v4, v51, v52
v_max3_u32 v4, v4, v53, v54
v_max3_u32 v4, v4, v55, v56
v_max3_u32 v4, v4, v57, v58
v_max3_u32 v4, v4, v59, v60
v_max3_u32 v4, v4, v61, v62
v_max3_u32 v4, v4, v63, v64
v_max3_u32 v4, v4, v65, v66
v_max3_u32 v4, v4, v67, v68
v_max3_u32 v4, v4, v69, v70
v_max_u32 v4, v4, v71
v_cmp_eq_u32 vcc, -1, v4
s_cbranch_vccnz M_poll
s_branch M_ok
F_fix:
s_sub_u32 s30, s30, 1
s_cbranch_scc1 F_ok
s_mov_b32 exec_hi, -1
s_and_b32 s25, s30, 63
s_cbranch_scc1 F_poll
v_max3_u32 v6, v48, v49, v50
v_max3_u32 v6, v6, v51, v52
v_max3_u32 v6, v6, v53, v54
v_max3_u32 v6, v6, v55, v56
v_max3_u32 v6, v6, v57, v58
v_max3_u32 v6, v6, v59, v60
v_max3_u32 v6, v6, v61, v62
v_max_u32 v6, v6, v63
v_cmp_eq_u32 vcc, -1, v6
s_cbranch_vccnz F_poll
s_mov_b32 exec_hi, s49
s_branch F_ok
K_streamer:
s_mul_i32 s16, s16, 3
s_add_u32 s16, s16, s18
s_sub_u32 s37, s16, 1
s_mov_b32 s38, s17
s_lshl_b32 s16, s37, 5
s_add_u32 s36, s16, s17
s_add_u32 s2, s36, 64
s_mov_b32 s39, s36
s_cmp_eq_u32 s3, 4
s_cbranch_scc0 K_n4
s_setprio 3
v_mov_b32 v2, v3
v_lshlrev_b32 v4, 4, v2
v_mul_u32_u24 v3, 1366, v2
v_add_u32 v3, 0, v3
v_bfe_u32 v3, v3, 16, 2
v_lshlrev_b32 v3, 6, v3
v_xor_b32 v10, v4, v3
v_mul_u32_u24 v3, 1366, v2
v_add_u32 v3, 87424, v3
v_bfe_u32 v3, v3, 16, 2
v_lshlrev_b32 v3, 6, v3
v_xor_b32 v11, v4, v3
v_mul_u32_u24 v3, 1366, v2
v_add_u32 v3, 174848, v3
v_bfe_u32 v3, v3, 16, 2
v_lshlrev_b32 v3, 6, v3
v_xor_b32 v12, v4, v3
v_xor_b32 v13, 32, v10
v_add_u32 v13, 3072, v13
v_xor_b32 v14, 32, v11
v_add_u32 v14, 3072, v14
v_xor_b32 v15, 32, v12
v_add_u32 v15, 3072, v15
s_mov_b32 s16, s39
s_mov_b32 s27, 0
s_mov_b32 s28, 0
s_mul_i32 s18, s16, 2731
s_lshr_b32 s18, s18, 16
s_mul_i32 s19, s18, 24
s_sub_u32 s19, s16, s19
s_mul_i32 s22, s18, 589824
s_mul_i32 s23, s19, 12288
s_add_u32 s22, s22, s23
s_add_u32 s23, s22, 6144
s_add_u32 s17, s22, 294912
s_add_u32 s26, s17, 6144
s_mul_i32 s24, s16, 6144
s_waitcnt lgkmcnt(0)
s_mov_b32 s12, s60
s_and_b32 s13, s61, 0xffff
s_mov_b32 s14, 28311552
s_mov_b32 s15, 0x20000
s_mov_b32 s8, s58
s_and_b32 s9, s59, 0xffff
s_mov_b32 s10, 113246208
s_mov_b32 s11, 0x20000
s_add_u32 m0, s27, 24576
s_nop 0
buffer_load_dwordx4 v10, s[12:15], s24 offen offset:0 nt lds
buffer_load_dwordx4 v11, s[12:15], s24 offen offset:1024 nt lds
buffer_load_dwordx4 v12, s[12:15], s24 offen offset:2048 nt lds
s_waitcnt vmcnt(30)
s_add_u32 m0, s27, 27648
s_nop 0
buffer_load_dwordx4 v13, s[12:15], s24 offen offset:0 nt lds
buffer_load_dwordx4 v14, s[12:15], s24 offen offset:1024 nt lds
buffer_load_dwordx4 v15, s[12:15], s24 offen offset:2048 nt lds
s_waitcnt vmcnt(30)
s_add_u32 m0, s27, 0
s_nop 0
buffer_load_dwordx4 v10, s[8:11], s22 offen offset:0 nt lds
buffer_load_dwordx4 v11, s[8:11], s22 offen offset:1024 nt lds
buffer_load_dwordx4 v12, s[8:11], s22 offen offset:2048 nt lds
s_waitcnt vmcnt(30)
s_add_u32 m0, s27, 3072
s_nop 0
buffer_load_dwordx4 v13, s[8:11], s22 offen offset:0 nt lds
buffer_load_dwordx4 v14, s[8:11], s22 offen offset:1024 nt lds
buffer_load_dwordx4 v15, s[8:11], s22 offen offset:2048 nt lds
s_waitcnt vmcnt(30)
s_add_u32 m0, s27, 6144
s_nop 0
buffer_load_dwordx4 v10, s[8:11], s23 offen offset:0 nt lds
buffer_load_dwordx4 v11, s[8:11], s23 offen offset:1024 nt lds
buffer_load_dwordx4 v12, s[8:11], s23 offen offset:2048 nt lds
s_waitcnt vmcnt(30)
s_add_u32 m0, s27, 9216
s_nop 0
buffer_load_dwordx4 v13, s[8:11], s23 offen offset:0 nt lds
buffer_load_dwordx4 v14, s[8:11], s23 offen offset:1024 nt lds
buffer_load_dwordx4 v15, s[8:11], s23 offen offset:2048 nt lds
s_waitcnt vmcnt(30)
s_add_u32 m0, s27, 12288
s_nop 0
buffer_load_dwordx4 v10, s[8:11], s17 offen offset:0 nt lds
buffer_load_dwordx4 v11, s[8:11], s17 offen offset:1024 nt lds
buffer_load_dwordx4 v12, s[8:11], s17 offen offset:2048 nt lds
s_waitcnt vmcnt(30)
s_add_u32 m0, s27, 15360
s_nop 0
buffer_load_dwordx4 v13, s[8:11], s17 offen offset:0 nt lds
buffer_load_dwordx4 v14, s[8:11], s17 offen offset:1024 nt lds
buffer_load_dwordx4 v15, s[8:11], s17 offen offset:2048 nt lds
s_waitcnt vmcnt(30)
s_add_u32 m0, s27, 18432
s_nop 0
buffer_load_dwordx4 v10, s[8:11], s26 offen offset:0 nt lds
buffer_load_dwordx4 v11, s[8:11], s26 offen offset:1024 nt lds
buffer_load_dwordx4 v12, s[8:11], s26 offen offset:2048 nt lds
s_waitcnt vmcnt(30)
s_add_u32 m0, s27, 21504
s_nop 0
buffer_load_dwordx4 v13, s[8:11], s26 offen offset:0 nt lds
buffer_load_dwordx4 v14, s[8:11], s26 offen offset:1024 nt lds
buffer_load_dwordx4 v15, s[8:11], s26 offen offset:2048 nt lds
s_waitcnt vmcnt(30)
s_mov_b32 s44, s28
s_add_u32 s16, s16, 192
s_add_u32 s27, s27, 30720
s_cmp_eq_u32 s27, 153600
s_cselect_b32 s27, 0, s27
s_add_u32 s28, s28, 1
s_mov_b32 s32, s54
s_and_b32 s33, s55, 0xffff
s_mov_b32 s34, 452984832
s_mov_b32 s35, 0x20000
v_mov_b32 v16, 161792
v_and_b32 v9, 3, v0
v_lshlrev_b32 v9, 2, v9
v_add_u32 v9, 161808, v9
s_mov_b64 s[50:51], 0
s_mov_b32 s46, -1
s_and_b32 s20, s36, 7
s_lshl_b32 s21, s20, 10
s_add_u32 s21, s21, 98304
s_add_u32 s20, s20, 4040
s_mov_b32 s47, 0
s_mul_i32 s40, s38, 6
s_lshr_b32 s40, s40, 5
s_lshl_b32 s45, 16640, s40
v_mov_b32 v19, 161864
s_barrier
v_and_b32 v21, 1, v0
v_lshlrev_b32 v21, 2, v21
v_add_u32 v21, 161920, v21
LD_loop0:
s_mul_i32 s18, s16, 2731
s_lshr_b32 s18, s18, 16
s_mul_i32 s19, s18, 24
s_sub_u32 s19, s16, s19
s_mul_i32 s22, s18, 589824
s_mul_i32 s23, s19, 12288
s_add_u32 s22, s22, s23
s_add_u32 s23, s22, 6144
s_add_u32 s17, s22, 294912
s_add_u32 s26, s17, 6144
s_mul_i32 s24, s16, 6144
s_mov_b32 s30, 256
LY18:
ds_read_b32 v17, v21
s_sub_u32 s30, s30, 1
s_cbranch_scc1 LY18x
s_waitcnt lgkmcnt(0)
v_cmp_eq_u32 vcc, 1, v17
s_cbranch_vccnz LY18
LY18x:
s_waitcnt lgkmcnt(0)
s_add_u32 m0, s27, 24576
s_nop 0
buffer_load_dwordx4 v10, s[12:15], s24 offen offset:0 nt lds
buffer_load_dwordx4 v11, s[12:15], s24 offen offset:1024 nt lds
buffer_load_dwordx4 v12, s[12:15], s24 offen offset:2048 nt lds
s_waitcnt vmcnt(30)
s_mov_b32 s30, 256
LY19:
ds_read_b32 v17, v21
s_sub_u32 s30, s30, 1
s_cbranch_scc1 LY19x
s_waitcnt lgkmcnt(0)
v_cmp_eq_u32 vcc, 1, v17
s_cbranch_vccnz LY19
LY19x:
s_waitcnt lgkmcnt(0)
s_add_u32 m0, s27, 27648
s_nop 0
buffer_load_dwordx4 v13, s[12:15], s24 offen offset:0 nt lds
buffer_load_dwordx4 v14, s[12:15], s24 offen offset:1024 nt lds
buffer_load_dwordx4 v15, s[12:15], s24 offen offset:2048 nt lds
s_waitcnt vmcnt(30)
s_mov_b32 s30, 256
LY20:
ds_read_b32 v17, v21
s_sub_u32 s30, s30, 1
s_cbranch_scc1 LY20x
s_waitcnt lgkmcnt(0)
v_cmp_eq_u32 vcc, 1, v17
s_cbranch_vccnz LY20
LY20x:
s_waitcnt lgkmcnt(0)
s_add_u32 m0, s27, 0
s_nop 0
buffer_load_dwordx4 v10, s[8:11], s22 offen offset:0 nt lds
buffer_load_dwordx4 v11, s[8:11], s22 offen offset:1024 nt lds
buffer_load_dwordx4 v12, s[8:11], s22 offen offset:2048 nt lds
s_waitcnt vmcnt(30)
s_mov_b32 s30, 256
LY21:
ds_read_b32 v17, v21
s_sub_u32 s30, s30, 1
s_cbranch_scc1 LY21x
s_waitcnt lgkmcnt(0)
v_cmp_eq_u32 vcc, 1, v17
s_cbranch_vccnz LY21
LY21x:
s_waitcnt lgkmcnt(0)
s_add_u32 m0, s27, 3072
s_nop 0
buffer_load_dwordx4 v13, s[8:11], s22 offen offset:0 nt lds
buffer_load_dwordx4 v14, s[8:11], s22 offen offset:1024 nt lds
buffer_load_dwordx4 v15, s[8:11], s22 offen offset:2048 nt lds
s_waitcnt vmcnt(30)
s_mov_b32 s30, 256
LY22:
ds_read_b32 v17, v21
s_sub_u32 s30, s30, 1
s_cbranch_scc1 LY22x
s_waitcnt lgkmcnt(0)
v_cmp_eq_u32 vcc, 1, v17
s_cbranch_vccnz LY22
LY22x:
s_waitcnt lgkmcnt(0)
s_add_u32 m0, s27, 6144
s_nop 0
buffer_load_dwordx4 v10, s[8:11], s23 offen offset:0 nt lds
buffer_load_dwordx4 v11, s[8:11], s23 offen offset:1024 nt lds
buffer_load_dwordx4 v12, s[8:11], s23 offen offset:2048 nt lds
s_waitcnt vmcnt(30)
s_mov_b32 s30, 256
LY23:
ds_read_b32 v17, v21
s_sub_u32 s30, s30, 1
s_cbranch_scc1 LY23x
s_waitcnt lgkmcnt(0)
v_cmp_eq_u32 vcc, 1, v17
s_cbranch_vccnz LY23
LY23x:
s_waitcnt lgkmcnt(0)
s_add_u32 m0, s27, 9216
s_nop 0
buffer_load_dwordx4 v13, s[8:11], s23 offen offset:0 nt lds
buffer_load_dwordx4 v14, s[8:11], s23 offen offset:1024 nt lds
buffer_load_dwordx4 v15, s[8:11], s23 offen offset:2048 nt lds
s_waitcnt vmcnt(30)
s_mov_b32 s30, 256
LY24:
ds_read_b32 v17, v21
s_sub_u32 s30, s30, 1
s_cbranch_scc1 LY24x
s_waitcnt lgkmcnt(0)
v_cmp_eq_u32 vcc, 1, v17
s_cbranch_vccnz LY24
LY24x:
s_waitcnt lgkmcnt(0)
s_add_u32 m0, s27, 12288
s_nop 0
buffer_load_dwordx4 v10, s[8:11], s17 offen offset:0 nt lds
buffer_load_dwordx4 v11, s[8:11], s17 offen offset:1024 nt lds
buffer_load_dwordx4 v12, s[8:11], s17 offen offset:2048 nt lds
s_waitcnt vmcnt(30)
s_mov_b32 s30, 256
LY25:
ds_read_b32 v17, v21
s_sub_u32 s30, s30, 1
s_cbranch_scc1 LY25x
s_waitcnt lgkmcnt(0)
v_cmp_eq_u32 vcc, 1, v17
s_cbranch_vccnz LY25
LY25x:
s_waitcnt lgkmcnt(0)
s_add_u32 m0, s27, 15360
s_nop 0
buffer_load_dwordx4 v13, s[8:11], s17 offen offset:0 nt lds
buffer_load_dwordx4 v14, s[8:11], s17 offen offset:1024 nt lds
buffer_load_dwordx4 v15, s[8:11], s17 offen offset:2048 nt lds
s_waitcnt vmcnt(30)
s_mov_b32 s30, 256
LY26:
ds_read_b32 v17, v21
s_sub_u32 s30, s30, 1
s_cbranch_scc1 LY26x
s_waitcnt lgkmcnt(0)
v_cmp_eq_u32 vcc, 1, v17
s_cbranch_vccnz LY26
LY26x:
s_waitcnt lgkmcnt(0)
s_add_u32 m0, s27, 18432
s_nop 0
buffer_load_dwordx4 v10, s[8:11], s26 offen offset:0 nt lds
buffer_load_dwordx4 v11, s[8:11], s26 offen offset:1024 nt lds
buffer_load_dwordx4 v12, s[8:11], s26 offen offset:2048 nt lds
s_waitcnt vmcnt(30)
s_mov_b32 s30, 256
LY27:
ds_read_b32 v17, v21
s_sub_u32 s30, s30, 1
s_cbranch_scc1 LY27x
s_waitcnt lgkmcnt(0)
v_cmp_eq_u32 vcc, 1, v17
s_cbranch_vccnz LY27
LY27x:
s_waitcnt lgkmcnt(0)
s_add_u32 m0, s27, 21504
s_nop 0
buffer_load_dwordx4 v13, s[8:11], s26 offen offset:0 nt lds
buffer_load_dwordx4 v14, s[8:11], s26 offen offset:1024 nt lds
buffer_load_dwordx4 v15, s[8:11], s26 offen offset:2048 nt lds
s_waitcnt vmcnt(30)
s_cmp_ge_u32 s28, s46
s_cbranch_scc1 LC28
LC28r:
v_mov_b32 v17, s28
ds_write_b32 v16, v17
s_mov_b32 s44, s28
s_add_u32 s16, s16, 192
s_add_u32 s27, s27, 30720
s_cmp_eq_u32 s27, 153600
s_cselect_b32 s27, 0, s27
s_add_u32 s28, s28, 1
s_cmp_lt_u32 s28, 5
s_cbranch_scc1 LD_loop0
LD_loop:
s_bitcmp1_b32 s45, s28
s_cbranch_scc1 LD_skip
LD_ns:
s_cmp_eq_u32 s28, 5
s_cselect_b32 s6, 384, 0
s_add_u32 s16, s16, s6
s_mul_i32 s18, s16, 2731
s_lshr_b32 s18, s18, 16
s_mul_i32 s19, s18, 24
s_sub_u32 s19, s16, s19
s_mul_i32 s22, s18, 589824
s_mul_i32 s23, s19, 12288
s_add_u32 s22, s22, s23
s_add_u32 s23, s22, 6144
s_add_u32 s17, s22, 294912
s_add_u32 s26, s17, 6144
s_mul_i32 s24, s16, 6144
s_cmp_lt_u32 s28, 5
s_cbranch_scc1 LD_go
s_sub_u32 s29, s28, 1
s_mov_b32 s30, 2097152
W29:
ds_read_b32 v17, v9 offset:0
s_sub_u32 s30, s30, 1
s_cselect_b32 s25, 0, s29
s_waitcnt lgkmcnt(0)
v_cmp_gt_u32 vcc, s25, v17
s_cbranch_vccnz W29
LD_go:
s_cmp_lt_u32 s28, 20
s_cbranch_scc1 LD_na
s_mov_b32 s31, 1
s_atomic_add s31, s[54:55], s21 glc
LD_na:
s_add_u32 m0, s27, 24576
s_nop 0
buffer_load_dwordx4 v10, s[12:15], s24 offen offset:0 nt lds
buffer_load_dwordx4 v11, s[12:15], s24 offen offset:1024 nt lds
buffer_load_dwordx4 v12, s[12:15], s24 offen offset:2048 nt lds
s_waitcnt vmcnt(30)
s_add_u32 m0, s27, 27648
s_nop 0
buffer_load_dwordx4 v13, s[12:15], s24 offen offset:0 nt lds
buffer_load_dwordx4 v14, s[12:15], s24 offen offset:1024 nt lds
buffer_load_dwordx4 v15, s[12:15], s24 offen offset:2048 nt lds
s_waitcnt vmcnt(30)
s_add_u32 m0, s27, 0
s_nop 0
buffer_load_dwordx4 v10, s[8:11], s22 offen offset:0 nt lds
buffer_load_dwordx4 v11, s[8:11], s22 offen offset:1024 nt lds
buffer_load_dwordx4 v12, s[8:11], s22 offen offset:2048 nt lds
s_waitcnt vmcnt(30)
s_add_u32 m0, s27, 3072
s_nop 0
buffer_load_dwordx4 v13, s[8:11], s22 offen offset:0 nt lds
buffer_load_dwordx4 v14, s[8:11], s22 offen offset:1024 nt lds
buffer_load_dwordx4 v15, s[8:11], s22 offen offset:2048 nt lds
s_waitcnt vmcnt(30)
s_add_u32 m0, s27, 6144
s_nop 0
buffer_load_dwordx4 v10, s[8:11], s23 offen offset:0 nt lds
buffer_load_dwordx4 v11, s[8:11], s23 offen offset:1024 nt lds
buffer_load_dwordx4 v12, s[8:11], s23 offen offset:2048 nt lds
s_waitcnt vmcnt(30)
s_add_u32 m0, s27, 9216
s_nop 0
buffer_load_dwordx4 v13, s[8:11], s23 offen offset:0 nt lds
buffer_load_dwordx4 v14, s[8:11], s23 offen offset:1024 nt lds
buffer_load_dwordx4 v15, s[8:11], s23 offen offset:2048 nt lds
s_waitcnt vmcnt(30)
s_add_u32 m0, s27, 12288
s_nop 0
buffer_load_dwordx4 v10, s[8:11], s17 offen offset:0 nt lds
buffer_load_dwordx4 v11, s[8:11], s17 offen offset:1024 nt lds
buffer_load_dwordx4 v12, s[8:11], s17 offen offset:2048 nt lds
s_waitcnt vmcnt(30)
s_add_u32 m0, s27, 15360
s_nop 0
buffer_load_dwordx4 v13, s[8:11], s17 offen offset:0 nt lds
buffer_load_dwordx4 v14, s[8:11], s17 offen offset:1024 nt lds
buffer_load_dwordx4 v15, s[8:11], s17 offen offset:2048 nt lds
s_waitcnt vmcnt(30)
s_add_u32 m0, s27, 18432
s_nop 0
buffer_load_dwordx4 v10, s[8:11], s26 offen offset:0 nt lds
buffer_load_dwordx4 v11, s[8:11], s26 offen offset:1024 nt lds
buffer_load_dwordx4 v12, s[8:11], s26 offen offset:2048 nt lds
s_waitcnt vmcnt(30)
s_add_u32 m0, s27, 21504
s_nop 0
buffer_load_dwordx4 v13, s[8:11], s26 offen offset:0 nt lds
buffer_load_dwordx4 v14, s[8:11], s26 offen offset:1024 nt lds
buffer_load_dwordx4 v15, s[8:11], s26 offen offset:2048 nt lds
s_waitcnt vmcnt(30)
s_cmp_ge_u32 s28, s46
s_cbranch_scc1 LC30
LC30r:
v_mov_b32 v17, s28
ds_write_b32 v16, v17
s_mov_b32 s44, s28
s_add_u32 s16, s16, 192
s_add_u32 s27, s27, 30720
s_cmp_eq_u32 s27, 153600
s_cselect_b32 s27, 0, s27
s_add_u32 s28, s28, 1
s_cmp_lt_u32 s28, 21
s_cbranch_scc1 LD_loop
s_waitcnt lgkmcnt(0)
s_lshl_b32 s16, s31, 3
s_add_u32 s16, s16, s20
s_cmp_lt_u32 s16, 4608
s_cbranch_scc1 LD_loop
v_mov_b32 v18, s28
ds_write_b32 v16, v18 offset:4
s_cmp_ge_u32 s28, s46
s_cbranch_scc1 LC31
LC31r:
v_mov_b32 v20, 1
v_mov_b32 v21, 2
s_waitcnt vmcnt(24)
ds_write_b32 v16, v20 offset:8
s_waitcnt vmcnt(12)
ds_write_b32 v16, v21 offset:8
s_waitcnt vmcnt(0)
ds_write_b32 v16, v18
s_mov_b32 s30, 2097152
W32:
ds_read_b32 v17, v16 offset:68
s_sub_u32 s30, s30, 1
s_cselect_b32 s25, 0, 1
s_waitcnt lgkmcnt(0)
v_cmp_gt_u32 vcc, s25, v17
s_cbranch_vccnz W32
s_mov_b32 s3, 0
s_mov_b32 s45, 0
s_branch K_rstage
LD_skip:
s_bitset0_b32 s45, s28
s_add_u32 s46, s28, 1
s_add_u32 s16, s16, 192
s_add_u32 s27, s27, 30720
s_cmp_eq_u32 s27, 153600
s_cselect_b32 s27, 0, s27
s_add_u32 s28, s28, 1
s_sub_u32 s16, s16, 192
s_branch LD_ns
LC28:
s_mov_b32 s30, 2097152
W33:
ds_read_b32 v17, v19 offset:0
s_sub_u32 s30, s30, 1
s_cselect_b32 s25, 0, 1
s_waitcnt lgkmcnt(0)
v_cmp_gt_u32 vcc, s25, v17
s_cbranch_vccnz W33
s_mov_b32 s46, -1
v_add_u32 v19, 4, v19
s_branch LC28r
LC30:
s_mov_b32 s30, 2097152
W34:
ds_read_b32 v17, v19 offset:0
s_sub_u32 s30, s30, 1
s_cselect_b32 s25, 0, 1
s_waitcnt lgkmcnt(0)
v_cmp_gt_u32 vcc, s25, v17
s_cbranch_vccnz W34
s_mov_b32 s46, -1
v_add_u32 v19, 4, v19
s_branch LC30r
LC31:
s_mov_b32 s30, 2097152
W35:
ds_read_b32 v17, v19 offset:0
s_sub_u32 s30, s30, 1
s_cselect_b32 s25, 0, 1
s_waitcnt lgkmcnt(0)
v_cmp_gt_u32 vcc, s25, v17
s_cbranch_vccnz W35
s_mov_b32 s46, -1
v_add_u32 v19, 4, v19
s_branch LC31r
K_n4:
s_waitcnt lgkmcnt(0)
s_mov_b32 s8, s58
s_and_b32 s9, s59, 0xffff
s_mov_b32 s10, 113246208
s_mov_b32 s11, 0x20000
s_mov_b32 s12, s60
s_and_b32 s13, s61, 0xffff
s_mov_b32 s14, 28311552
s_mov_b32 s15, 0x20000
s_mov_b32 s32, s54
s_and_b32 s33, s55, 0xffff
s_mov_b32 s34, 452984832
s_mov_b32 s35, 0x20000
s_mov_b32 s88, s52
s_and_b32 s89, s53, 0xffff
s_mov_b32 s90, 256
s_mov_b32 s91, 0x20000
s_cmp_lt_u32 s3, 2
s_cbranch_scc1 K_x
s_cmp_eq_u32 s3, 5
s_cbranch_scc0 K_y
v_and_b32 v3, 63, v0
v_lshlrev_b32 v8, 4, v3
v_mov_b32 v19, 161792
v_mov_b32 v20, 0
v_mov_b32 v21, 0
v_mov_b32 v22, 0
v_mov_b32 v23, 0
v_add_u32 v4, 161792, v8
ds_write_b128 v4, v[20:23]
v_mov_b32 v4, 156288
ds_write_b128 v4, v[20:23]
ds_write_b128 v4, v[20:23] offset:2704
ds_write_b128 v4, v[20:23] offset:5408
v_mov_b32 v5, 1
v_mov_b32 v6, 0xff800000
ds_write_b32 v19, v6 offset:4
v_mov_b32 v24, 3
v_mov_b32 v25, 3
v_mov_b32 v26, 3
v_mov_b32 v27, 3
ds_write_b128 v19, v[24:27] offset:16
s_waitcnt lgkmcnt(0)
s_barrier
s_mov_b32 s30, 2097152
W36:
ds_read_b32 v6, v19 offset:0
s_sub_u32 s30, s30, 1
s_cselect_b32 s25, 0, 1
s_waitcnt lgkmcnt(0)
v_cmp_gt_u32 vcc, s25, v6
s_cbranch_vccz W36x
s_sleep 2
s_branch W36
W36x:
s_mov_b32 s30, 2097152
W37:
buffer_load_dwordx2 v[24:25], off, s[88:91], 0 sc1
buffer_load_dwordx2 v[26:27], off, s[88:91], 0 offset:128 sc1
s_sub_u32 s30, s30, 1
s_cselect_b32 s25, 0, 1
s_waitcnt vmcnt(0)
v_min3_u32 v24, v24, v25, v26
v_min_u32 v24, v24, v27
v_cmp_gt_u32 vcc, s25, v24
s_cbranch_vccz W37x
s_sleep 2
s_branch W37
W37x:
ds_write_b32 v19, v5 offset:64
s_lshl_b32 s46, s37, 10
s_add_u32 s46, s46, 114688
s_getreg_b32 s24, hwreg(HW_REG_XCC_ID, 0, 3)
s_lshl_b32 s24, s24, 3
s_lshl_b64 s[6:7], 1, s24
s_atomic_add_x2 s[6:7], s[54:55], s46 glc
s_waitcnt lgkmcnt(0)
v_mov_b32 v2, v3
v_and_b32 v9, 3, v0
v_lshlrev_b32 v9, 2, v9
v_add_u32 v9, 161808, v9
v_and_b32 v1, 1, v0
v_lshlrev_b32 v1, 2, v1
v_add_u32 v1, 161792, v1
v_lshlrev_b32 v4, 4, v2
v_mul_u32_u24 v3, 1366, v2
v_add_u32 v3, 0, v3
v_bfe_u32 v3, v3, 16, 2
v_lshlrev_b32 v3, 6, v3
v_xor_b32 v10, v4, v3
v_mul_u32_u24 v3, 1366, v2
v_add_u32 v3, 87424, v3
v_bfe_u32 v3, v3, 16, 2
v_lshlrev_b32 v3, 6, v3
v_xor_b32 v11, v4, v3
v_mul_u32_u24 v3, 1366, v2
v_add_u32 v3, 174848, v3
v_bfe_u32 v3, v3, 16, 2
v_lshlrev_b32 v3, 6, v3
v_xor_b32 v12, v4, v3
v_xor_b32 v13, 32, v10
v_add_u32 v13, 3072, v13
v_xor_b32 v14, 32, v11
v_add_u32 v14, 3072, v14
v_xor_b32 v15, 32, v12
v_add_u32 v15, 3072, v15
s_mul_i32 s40, s38, 6
s_lshr_b32 s40, s40, 5
s_mov_b32 s30, 2097152
W38:
ds_read_b32 v6, v19 offset:0
s_sub_u32 s30, s30, 1
s_cselect_b32 s25, 0, 4
s_waitcnt lgkmcnt(0)
v_cmp_gt_u32 vcc, s25, v6
s_cbranch_vccz W38x
s_sleep 2
s_branch W38
W38x:
s_mov_b32 s30, 2097152
W39:
ds_read_b32 v6, v1 offset:128
s_sub_u32 s30, s30, 1
s_cselect_b32 s25, 0, 2
s_waitcnt lgkmcnt(0)
v_cmp_gt_u32 vcc, s25, v6
s_cbranch_vccz W39x
s_sleep 1
s_branch W39
W39x:
s_add_u32 s16, s39, 960
s_mul_i32 s18, s16, 2731
s_lshr_b32 s18, s18, 16
s_mul_i32 s19, s18, 24
s_sub_u32 s19, s16, s19
s_mul_i32 s22, s18, 589824
s_mul_i32 s23, s19, 12288
s_add_u32 s22, s22, s23
s_add_u32 s23, s22, 6144
s_add_u32 s17, s22, 294912
s_add_u32 s26, s17, 6144
s_mul_i32 s24, s16, 6144
buffer_load_dwordx4 v[16:19], v10, s[12:15], s24 offen offset:0 nt
buffer_load_dwordx4 v[20:23], v11, s[12:15], s24 offen offset:1024 nt
buffer_load_dwordx4 v[24:27], v12, s[12:15], s24 offen offset:2048 nt
s_waitcnt vmcnt(27)
buffer_load_dwordx4 v[28:31], v13, s[12:15], s24 offen offset:0 nt
buffer_load_dwordx4 v[32:35], v14, s[12:15], s24 offen offset:1024 nt
buffer_load_dwordx4 v[36:39], v15, s[12:15], s24 offen offset:2048 nt
s_waitcnt vmcnt(27)
buffer_load_dwordx4 v[40:43], v10, s[8:11], s22 offen offset:0 nt
buffer_load_dwordx4 v[44:47], v11, s[8:11], s22 offen offset:1024 nt
buffer_load_dwordx4 v[48:51], v12, s[8:11], s22 offen offset:2048 nt
s_waitcnt vmcnt(27)
buffer_load_dwordx4 v[52:55], v13, s[8:11], s22 offen offset:0 nt
buffer_load_dwordx4 v[56:59], v14, s[8:11], s22 offen offset:1024 nt
buffer_load_dwordx4 v[60:63], v15, s[8:11], s22 offen offset:2048 nt
s_waitcnt vmcnt(27)
buffer_load_dwordx4 v[64:67], v10, s[8:11], s23 offen offset:0 nt
buffer_load_dwordx4 v[68:71], v11, s[8:11], s23 offen offset:1024 nt
buffer_load_dwordx4 v[72:75], v12, s[8:11], s23 offen offset:2048 nt
s_waitcnt vmcnt(27)
buffer_load_dwordx4 v[76:79], v13, s[8:11], s23 offen offset:0 nt
buffer_load_dwordx4 v[80:83], v14, s[8:11], s23 offen offset:1024 nt
buffer_load_dwordx4 v[84:87], v15, s[8:11], s23 offen offset:2048 nt
s_waitcnt vmcnt(27)
buffer_load_dwordx4 v[88:91], v10, s[8:11], s17 offen offset:0 nt
buffer_load_dwordx4 v[92:95], v11, s[8:11], s17 offen offset:1024 nt
buffer_load_dwordx4 v[96:99], v12, s[8:11], s17 offen offset:2048 nt
s_waitcnt vmcnt(27)
buffer_load_dwordx4 v[100:103], v13, s[8:11], s17 offen offset:0 nt
buffer_load_dwordx4 v[104:107], v14, s[8:11], s17 offen offset:1024 nt
buffer_load_dwordx4 v[108:111], v15, s[8:11], s17 offen offset:2048 nt
s_waitcnt vmcnt(27)
buffer_load_dwordx4 v[112:115], v10, s[8:11], s26 offen offset:0 nt
buffer_load_dwordx4 v[116:119], v11, s[8:11], s26 offen offset:1024 nt
buffer_load_dwordx4 v[120:123], v12, s[8:11], s26 offen offset:2048 nt
s_waitcnt vmcnt(27)
buffer_load_dwordx4 v[124:127], v13, s[8:11], s26 offen offset:0 nt
buffer_load_dwordx4 v[128:131], v14, s[8:11], s26 offen offset:1024 nt
buffer_load_dwordx4 v[132:135], v15, s[8:11], s26 offen offset:2048 nt
s_waitcnt vmcnt(27)
s_add_u32 s16, s39, 1152
s_mul_i32 s18, s16, 2731
s_lshr_b32 s18, s18, 16
s_mul_i32 s19, s18, 24
s_sub_u32 s19, s16, s19
s_mul_i32 s22, s18, 589824
s_mul_i32 s23, s19, 12288
s_add_u32 s22, s22, s23
s_add_u32 s23, s22, 6144
s_add_u32 s17, s22, 294912
s_add_u32 s26, s17, 6144
s_mul_i32 s24, s16, 6144
buffer_load_dwordx4 v[136:139], v10, s[12:15], s24 offen offset:0 nt
buffer_load_dwordx4 v[140:143], v11, s[12:15], s24 offen offset:1024 nt
buffer_load_dwordx4 v[144:147], v12, s[12:15], s24 offen offset:2048 nt
s_waitcnt vmcnt(27)
buffer_load_dwordx4 v[148:151], v13, s[12:15], s24 offen offset:0 nt
buffer_load_dwordx4 v[152:155], v14, s[12:15], s24 offen offset:1024 nt
buffer_load_dwordx4 v[156:159], v15, s[12:15], s24 offen offset:2048 nt
s_waitcnt vmcnt(27)
buffer_load_dwordx4 v[160:163], v10, s[8:11], s22 offen offset:0 nt
buffer_load_dwordx4 v[164:167], v11, s[8:11], s22 offen offset:1024 nt
buffer_load_dwordx4 v[168:171], v12, s[8:11], s22 offen offset:2048 nt
s_waitcnt vmcnt(27)
buffer_load_dwordx4 v[172:175], v13, s[8:11], s22 offen offset:0 nt
buffer_load_dwordx4 v[176:179], v14, s[8:11], s22 offen offset:1024 nt
buffer_load_dwordx4 v[180:183], v15, s[8:11], s22 offen offset:2048 nt
s_waitcnt vmcnt(27)
buffer_load_dwordx4 v[184:187], v10, s[8:11], s23 offen offset:0 nt
buffer_load_dwordx4 v[188:191], v11, s[8:11], s23 offen offset:1024 nt
buffer_load_dwordx4 v[192:195], v12, s[8:11], s23 offen offset:2048 nt
s_waitcnt vmcnt(27)
buffer_load_dwordx4 v[196:199], v13, s[8:11], s23 offen offset:0 nt
buffer_load_dwordx4 v[200:203], v14, s[8:11], s23 offen offset:1024 nt
buffer_load_dwordx4 v[204:207], v15, s[8:11], s23 offen offset:2048 nt
s_waitcnt vmcnt(27)
buffer_load_dwordx4 v[208:211], v10, s[8:11], s17 offen offset:0 nt
buffer_load_dwordx4 v[212:215], v11, s[8:11], s17 offen offset:1024 nt
buffer_load_dwordx4 v[216:219], v12, s[8:11], s17 offen offset:2048 nt
s_waitcnt vmcnt(27)
buffer_load_dwordx4 v[220:223], v13, s[8:11], s17 offen offset:0 nt
buffer_load_dwordx4 v[224:227], v14, s[8:11], s17 offen offset:1024 nt
buffer_load_dwordx4 v[228:231], v15, s[8:11], s17 offen offset:2048 nt
s_waitcnt vmcnt(27)
buffer_load_dwordx4 v[232:235], v10, s[8:11], s26 offen offset:0 nt
buffer_load_dwordx4 v[236:239], v11, s[8:11], s26 offen offset:1024 nt
buffer_load_dwordx4 v[240:243], v12, s[8:11], s26 offen offset:2048 nt
s_waitcnt vmcnt(27)
buffer_load_dwordx4 v[244:247], v13, s[8:11], s26 offen offset:0 nt
buffer_load_dwordx4 v[248:251], v14, s[8:11], s26 offen offset:1024 nt
buffer_load_dwordx4 v[252:255], v15, s[8:11], s26 offen offset:2048 nt
s_waitcnt vmcnt(27)
s_add_u32 s16, s40, 8
s_mul_i32 s6, s16, 205
s_lshr_b32 s6, s6, 10
s_mul_i32 s6, s6, 5
s_sub_u32 s6, s16, s6
s_mul_i32 s6, s6, 30720
v_add_u32 v7, s6, v8
s_sub_u32 s16, s16, 1
s_mov_b32 s30, 2097152
W40:
ds_read_b32 v6, v9 offset:0
s_sub_u32 s30, s30, 1
s_cselect_b32 s25, 0, s16
s_waitcnt lgkmcnt(0)
v_cmp_gt_u32 vcc, s25, v6
s_cbranch_vccz W40x
s_sleep 1
s_branch W40
W40x:
s_waitcnt vmcnt(0)
ds_write_b128 v7, v[16:19] offset:24576
ds_write_b128 v7, v[20:23] offset:25600
ds_write_b128 v7, v[24:27] offset:26624
ds_write_b128 v7, v[28:31] offset:27648
ds_write_b128 v7, v[32:35] offset:28672
ds_write_b128 v7, v[36:39] offset:29696
s_waitcnt lgkmcnt(4)
ds_write_b128 v7, v[40:43] offset:0
ds_write_b128 v7, v[44:47] offset:1024
ds_write_b128 v7, v[48:51] offset:2048
ds_write_b128 v7, v[52:55] offset:3072
ds_write_b128 v7, v[56:59] offset:4096
ds_write_b128 v7, v[60:63] offset:5120
s_waitcnt lgkmcnt(4)
ds_write_b128 v7, v[64:67] offset:6144
ds_write_b128 v7, v[68:71] offset:7168
ds_write_b128 v7, v[72:75] offset:8192
ds_write_b128 v7, v[76:79] offset:9216
ds_write_b128 v7, v[80:83] offset:10240
ds_write_b128 v7, v[84:87] offset:11264
s_waitcnt lgkmcnt(4)
ds_write_b128 v7, v[88:91] offset:12288
ds_write_b128 v7, v[92:95] offset:13312
ds_write_b128 v7, v[96:99] offset:14336
ds_write_b128 v7, v[100:103] offset:15360
ds_write_b128 v7, v[104:107] offset:16384
ds_write_b128 v7, v[108:111] offset:17408
s_waitcnt lgkmcnt(4)
ds_write_b128 v7, v[112:115] offset:18432
ds_write_b128 v7, v[116:119] offset:19456
ds_write_b128 v7, v[120:123] offset:20480
ds_write_b128 v7, v[124:127] offset:21504
ds_write_b128 v7, v[128:131] offset:22528
ds_write_b128 v7, v[132:135] offset:23552
s_waitcnt lgkmcnt(4)
v_mov_b32 v6, 161864
ds_write_b32 v6, v5
s_add_u32 s16, s40, 14
s_mul_i32 s6, s16, 205
s_lshr_b32 s6, s6, 10
s_mul_i32 s6, s6, 5
s_sub_u32 s6, s16, s6
s_mul_i32 s6, s6, 30720
v_add_u32 v7, s6, v8
s_sub_u32 s16, s16, 1
s_mov_b32 s30, 2097152
W41:
ds_read_b32 v6, v9 offset:0
s_sub_u32 s30, s30, 1
s_cselect_b32 s25, 0, s16
s_waitcnt lgkmcnt(0)
v_cmp_gt_u32 vcc, s25, v6
s_cbranch_vccz W41x
s_sleep 1
s_branch W41
W41x:
s_waitcnt vmcnt(0)
ds_write_b128 v7, v[136:139] offset:24576
ds_write_b128 v7, v[140:143] offset:25600
ds_write_b128 v7, v[144:147] offset:26624
ds_write_b128 v7, v[148:151] offset:27648
ds_write_b128 v7, v[152:155] offset:28672
ds_write_b128 v7, v[156:159] offset:29696
s_waitcnt lgkmcnt(4)
ds_write_b128 v7, v[160:163] offset:0
ds_write_b128 v7, v[164:167] offset:1024
ds_write_b128 v7, v[168:171] offset:2048
ds_write_b128 v7, v[172:175] offset:3072
ds_write_b128 v7, v[176:179] offset:4096
ds_write_b128 v7, v[180:183] offset:5120
s_waitcnt lgkmcnt(4)
ds_write_b128 v7, v[184:187] offset:6144
ds_write_b128 v7, v[188:191] offset:7168
ds_write_b128 v7, v[192:195] offset:8192
ds_write_b128 v7, v[196:199] offset:9216
ds_write_b128 v7, v[200:203] offset:10240
ds_write_b128 v7, v[204:207] offset:11264
s_waitcnt lgkmcnt(4)
ds_write_b128 v7, v[208:211] offset:12288
ds_write_b128 v7, v[212:215] offset:13312
ds_write_b128 v7, v[216:219] offset:14336
ds_write_b128 v7, v[220:223] offset:15360
ds_write_b128 v7, v[224:227] offset:16384
ds_write_b128 v7, v[228:231] offset:17408
s_waitcnt lgkmcnt(4)
ds_write_b128 v7, v[232:235] offset:18432
ds_write_b128 v7, v[236:239] offset:19456
ds_write_b128 v7, v[240:243] offset:20480
ds_write_b128 v7, v[244:247] offset:21504
ds_write_b128 v7, v[248:251] offset:22528
ds_write_b128 v7, v[252:255] offset:23552
s_waitcnt lgkmcnt(4)
v_mov_b32 v6, 161868
ds_write_b32 v6, v5
v_mov_b32 v19, 161792
s_mov_b32 s30, 2097152
W42:
ds_read_b32 v6, v19 offset:0
s_sub_u32 s30, s30, 1
s_cselect_b32 s25, 0, 12
s_waitcnt lgkmcnt(0)
v_cmp_gt_u32 vcc, s25, v6
s_cbranch_vccz W42x
s_sleep 8
s_branch W42
W42x:
s_mov_b32 s30, 2097152
W43:
s_load_dwordx2 s[28:29], s[54:55], s46 glc
s_waitcnt lgkmcnt(0)
s_add_u32 s6, s28, 1
s_addc_u32 s7, s29, 0
s_add_u32 s24, s6, s7
s_mul_i32 s24, s24, 0x01010101
s_lshr_b32 s24, s24, 24
s_cmp_eq_u32 s24, 96
s_cbranch_scc1 W43x
s_sleep 32
s_sub_u32 s30, s30, 1
s_cbranch_scc0 W43
W43x:
s_getreg_b32 s24, hwreg(HW_REG_XCC_ID, 0, 3)
s_lshl_b32 s24, s24, 3
s_lshr_b64 s[6:7], s[6:7], s24
s_and_b32 s6, s6, 0x3f
s_cmp_eq_u32 s6, 32
s_cselect_b32 s45, 2, 1
v_mov_b32 v6, s45
ds_write_b32 v19, v6 offset:68
s_mov_b32 s30, 2097152
W44:
ds_read_b64 v[6:7], v19
s_sub_u32 s30, s30, 1
s_cbranch_scc1 W44x
s_waitcnt lgkmcnt(0)
v_cmp_gt_i32 vcc, 0, v7
s_cbranch_vccz W44x
s_sleep 2
s_branch W44
W44x:
s_mov_b32 s3, 1
s_cmp_eq_u32 s45, 2
s_cbranch_scc0 K_rstage
s_mul_i32 s6, s36, 49152
s_add_u32 s6, s6, 3145728
v_lshlrev_b32 v6, 3, v8
buffer_load_dword v48, v6, s[32:35], s6 offen sc1
s_add_u32 s6, s6, 8192
buffer_load_dword v49, v6, s[32:35], s6 offen sc1
s_add_u32 s6, s6, 8192
buffer_load_dword v50, v6, s[32:35], s6 offen sc1
s_add_u32 s6, s6, 8192
buffer_load_dword v51, v6, s[32:35], s6 offen sc1
s_add_u32 s6, s6, 8192
buffer_load_dword v52, v6, s[32:35], s6 offen sc1
s_add_u32 s6, s6, 8192
buffer_load_dword v53, v6, s[32:35], s6 offen sc1
s_add_u32 s6, s6, 8192
K_rstage:
v_and_b32 v1, 15, v0
v_bfe_u32 v2, v0, 4, 2
v_and_b32 v3, 7, v1
v_lshrrev_b32 v4, 3, v1
v_lshl_add_u32 v5, v3, 2, v2
v_lshlrev_b32 v16, 7, v5
v_lshlrev_b32 v9, 8, v5
v_lshl_add_u32 v9, v4, 4, v9
v_lshlrev_b32 v12, 4, v4
s_lshl_b32 s40, s37, 13
s_lshr_b32 s6, s38, 2
s_lshl_b32 s6, s6, 5
s_add_u32 s40, s40, s6
s_add_u32 s40, s40, 2097152
s_lshl_b32 s42, s37, 12
s_and_b32 s6, s38, 3
s_lshl_b32 s6, s6, 2
s_add_u32 s42, s42, s6
s_add_u32 s42, s42, 2146304
v_bfe_u32 v5, v1, 1, 2
v_mul_u32_u24 v3, 0x0202, v5
v_add_u32 v3, 0x0100, v3
v_and_b32 v4, 1, v1
v_lshlrev_b32 v4, 4, v4
v_lshlrev_b32 v3, v4, v3
v_mov_b32 v6, 0x0c0c0000
v_lshrrev_b32 v6, v4, v6
v_or_b32 v4, v3, v6
v_mov_b32 v6, 0x0c0c0c0c
v_cmp_eq_u32 vcc, 0, v5
s_nop 1
v_cndmask_b32 v20, v6, v4, vcc
v_cmp_eq_u32 vcc, 1, v5
s_nop 1
v_cndmask_b32 v21, v6, v4, vcc
v_cmp_eq_u32 vcc, 2, v5
s_nop 1
v_cndmask_b32 v22, v6, v4, vcc
v_cmp_eq_u32 vcc, 3, v5
s_nop 1
v_cndmask_b32 v23, v6, v4, vcc
v_mul_u32_u24 v10, 1536, v2
v_lshl_add_u32 v10, v1, 4, v10
s_mul_i32 s41, s36, 49152
s_add_u32 s41, s41, 3145728
s_lshl_b32 s6, s3, 8
s_add_u32 s56, s41, s6
v_and_b32 v18, 63, v0
v_lshlrev_b32 v18, 2, v18
s_mul_i32 s43, s38, 12
s_add_u32 s43, s43, s37
s_mul_i32 s43, s43, 896
s_add_u32 s43, s43, 2170880
s_mul_i32 s48, s3, 5376
s_add_u32 s48, s48, s43
s_mov_b32 s44, 0
s_mov_b32 s30, 2097152
s_add_u32 s57, s56, 6144
s_add_u32 s58, s57, 6144
s_add_u32 s59, s58, 6144
s_add_u32 s60, s59, 6144
s_add_u32 s61, s60, 6144
s_add_u32 s62, s61, 6144
s_add_u32 s63, s62, 6144
buffer_load_dword v17, v16, s[32:35], s42 offen sc1
R_a:
buffer_load_dwordx4 v[28:31], v9, s[32:35], s40 offen sc1
s_sub_u32 s30, s30, 1
s_cbranch_scc1 R_a2
s_waitcnt vmcnt(0)
v_max3_u32 v3, v28, v29, v30
v_max_u32 v3, v3, v31
v_cmp_eq_u32 vcc, -1, v3
s_cbranch_vccz R_a2
s_sleep 2
s_branch R_a
R_a2:
s_waitcnt vmcnt(0)
v_mov_b32 v4, v28
v_mov_b32 v6, v30
s_nop 0
v_max_f32_dpp v4, v4, v4 quad_perm:[1,0,3,2] row_mask:0xf bank_mask:0xf
v_max_f32_dpp v6, v6, v6 quad_perm:[1,0,3,2] row_mask:0xf bank_mask:0xf
s_nop 0
v_max_f32_dpp v4, v4, v4 quad_perm:[2,3,0,1] row_mask:0xf bank_mask:0xf
v_max_f32_dpp v6, v6, v6 quad_perm:[2,3,0,1] row_mask:0xf bank_mask:0xf
s_nop 0
v_max_f32_dpp v4, v4, v4 row_half_mirror row_mask:0xf bank_mask:0xf
v_max_f32_dpp v6, v6, v6 row_half_mirror row_mask:0xf bank_mask:0xf
v_mov_b32 v14, v4
v_mov_b32 v15, v6
s_nop 0
v_permlane32_swap_b32 v14, v4
v_permlane32_swap_b32 v15, v6
s_nop 0
v_max_f32 v4, v4, v14
v_max_f32 v6, v6, v15
v_mov_b32 v14, v4
v_mov_b32 v15, v6
s_nop 0
v_permlane16_swap_b32 v14, v4
v_permlane16_swap_b32 v15, v6
s_nop 0
v_max_f32 v4, v4, v14
v_max_f32 v6, v6, v15
v_sub_f32 v28, v28, v4
v_sub_f32 v30, v30, v6
v_exp_f32 v28, v28
v_exp_f32 v30, v30
s_nop 0
v_cvt_pk_bf16_f32 v11, v28, v30
v_lshlrev_b32 v5, 16, v11
v_and_b32 v7, 0xffff0000, v11
v_mul_f32 v5, v5, v29
v_mul_f32 v7, v7, v31
v_mov_b32_dpp v13, v11 row_newbcast:0 row_mask:0xf bank_mask:0xf
v_mov_b32_dpp v14, v11 row_newbcast:8 row_mask:0xf bank_mask:0xf
v_perm_b32 v160, v14, v13, v20
v_perm_b32 v161, v14, v13, v21
v_perm_b32 v162, v14, v13, v22
v_perm_b32 v163, v14, v13, v23
v_mov_b32_dpp v13, v11 row_newbcast:1 row_mask:0xf bank_mask:0xf
v_mov_b32_dpp v14, v11 row_newbcast:9 row_mask:0xf bank_mask:0xf
v_perm_b32 v164, v14, v13, v20
v_perm_b32 v165, v14, v13, v21
v_perm_b32 v166, v14, v13, v22
v_perm_b32 v167, v14, v13, v23
v_mov_b32_dpp v13, v11 row_newbcast:2 row_mask:0xf bank_mask:0xf
v_mov_b32_dpp v14, v11 row_newbcast:10 row_mask:0xf bank_mask:0xf
v_perm_b32 v168, v14, v13, v20
v_perm_b32 v169, v14, v13, v21
v_perm_b32 v170, v14, v13, v22
v_perm_b32 v171, v14, v13, v23
v_mov_b32_dpp v13, v11 row_newbcast:3 row_mask:0xf bank_mask:0xf
v_mov_b32_dpp v14, v11 row_newbcast:11 row_mask:0xf bank_mask:0xf
v_perm_b32 v172, v14, v13, v20
v_perm_b32 v173, v14, v13, v21
v_perm_b32 v174, v14, v13, v22
v_perm_b32 v175, v14, v13, v23
v_mov_b32_dpp v13, v11 row_newbcast:4 row_mask:0xf bank_mask:0xf
v_mov_b32_dpp v14, v11 row_newbcast:12 row_mask:0xf bank_mask:0xf
v_perm_b32 v176, v14, v13, v20
v_perm_b32 v177, v14, v13, v21
v_perm_b32 v178, v14, v13, v22
v_perm_b32 v179, v14, v13, v23
v_mov_b32_dpp v13, v11 row_newbcast:5 row_mask:0xf bank_mask:0xf
v_mov_b32_dpp v14, v11 row_newbcast:13 row_mask:0xf bank_mask:0xf
v_perm_b32 v180, v14, v13, v20
v_perm_b32 v181, v14, v13, v21
v_perm_b32 v182, v14, v13, v22
v_perm_b32 v183, v14, v13, v23
v_mov_b32_dpp v13, v11 row_newbcast:6 row_mask:0xf bank_mask:0xf
v_mov_b32_dpp v14, v11 row_newbcast:14 row_mask:0xf bank_mask:0xf
v_perm_b32 v184, v14, v13, v20
v_perm_b32 v185, v14, v13, v21
v_perm_b32 v186, v14, v13, v22
v_perm_b32 v187, v14, v13, v23
v_mov_b32_dpp v13, v11 row_newbcast:7 row_mask:0xf bank_mask:0xf
v_mov_b32_dpp v14, v11 row_newbcast:15 row_mask:0xf bank_mask:0xf
v_perm_b32 v188, v14, v13, v20
v_perm_b32 v189, v14, v13, v21
v_perm_b32 v190, v14, v13, v22
v_perm_b32 v191, v14, v13, v23
s_mov_b32 s30, 2097152
R_b:
buffer_load_dword v17, v16, s[32:35], s42 offen sc1
s_sub_u32 s30, s30, 1
s_cbranch_scc1 R_b1
s_waitcnt vmcnt(0)
v_cmp_eq_u32 vcc, -1, v17
s_cbranch_vccnz R_b
R_b1:
buffer_load_dwordx4 v[64:67], v10, s[32:35], s56 offen offset:0 sc1
buffer_load_dwordx4 v[68:71], v10, s[32:35], s56 offen offset:512 sc1
buffer_load_dwordx4 v[72:75], v10, s[32:35], s56 offen offset:1024 sc1
buffer_load_dwordx4 v[76:79], v10, s[32:35], s57 offen offset:0 sc1
buffer_load_dwordx4 v[80:83], v10, s[32:35], s57 offen offset:512 sc1
buffer_load_dwordx4 v[84:87], v10, s[32:35], s57 offen offset:1024 sc1
buffer_load_dwordx4 v[88:91], v10, s[32:35], s58 offen offset:0 sc1
buffer_load_dwordx4 v[92:95], v10, s[32:35], s58 offen offset:512 sc1
buffer_load_dwordx4 v[96:99], v10, s[32:35], s58 offen offset:1024 sc1
buffer_load_dwordx4 v[100:103], v10, s[32:35], s59 offen offset:0 sc1
buffer_load_dwordx4 v[104:107], v10, s[32:35], s59 offen offset:512 sc1
buffer_load_dwordx4 v[108:111], v10, s[32:35], s59 offen offset:1024 sc1
s_nop 0
v_add_f32_dpp v5, v5, v5 quad_perm:[1,0,3,2] row_mask:0xf bank_mask:0xf
v_add_f32_dpp v7, v7, v7 quad_perm:[1,0,3,2] row_mask:0xf bank_mask:0xf
s_nop 0
v_add_f32_dpp v5, v5, v5 quad_perm:[2,3,0,1] row_mask:0xf bank_mask:0xf
v_add_f32_dpp v7, v7, v7 quad_perm:[2,3,0,1] row_mask:0xf bank_mask:0xf
s_nop 0
v_add_f32_dpp v5, v5, v5 row_half_mirror row_mask:0xf bank_mask:0xf
v_add_f32_dpp v7, v7, v7 row_half_mirror row_mask:0xf bank_mask:0xf
v_mov_b32 v14, v5
v_mov_b32 v15, v7
s_nop 0
v_permlane32_swap_b32 v14, v5
v_permlane32_swap_b32 v15, v7
s_nop 0
v_add_f32 v5, v5, v14
v_add_f32 v7, v7, v15
v_mov_b32 v14, v5
v_mov_b32 v15, v7
s_nop 0
v_permlane16_swap_b32 v14, v5
v_permlane16_swap_b32 v15, v7
s_nop 0
v_add_f32 v5, v5, v14
v_add_f32 v7, v7, v15
buffer_load_dwordx4 v[112:115], v10, s[32:35], s60 offen offset:0 sc1
buffer_load_dwordx4 v[116:119], v10, s[32:35], s60 offen offset:512 sc1
buffer_load_dwordx4 v[120:123], v10, s[32:35], s60 offen offset:1024 sc1
s_waitcnt vmcnt(12)
v_mfma_f32_16x16x32_bf16 v[32:35], v[160:163], v[64:67], 0
v_mfma_f32_16x16x32_bf16 v[36:39], v[160:163], v[68:71], 0
v_mfma_f32_16x16x32_bf16 v[40:43], v[160:163], v[72:75], 0
buffer_load_dwordx4 v[124:127], v10, s[32:35], s61 offen offset:0 sc1
buffer_load_dwordx4 v[128:131], v10, s[32:35], s61 offen offset:512 sc1
buffer_load_dwordx4 v[132:135], v10, s[32:35], s61 offen offset:1024 sc1
s_waitcnt vmcnt(12)
v_mfma_f32_16x16x32_bf16 v[32:35], v[164:167], v[76:79], v[32:35]
v_mfma_f32_16x16x32_bf16 v[36:39], v[164:167], v[80:83], v[36:39]
v_mfma_f32_16x16x32_bf16 v[40:43], v[164:167], v[84:87], v[40:43]
buffer_load_dwordx4 v[136:139], v10, s[32:35], s62 offen offset:0 sc1
buffer_load_dwordx4 v[140:143], v10, s[32:35], s62 offen offset:512 sc1
buffer_load_dwordx4 v[144:147], v10, s[32:35], s62 offen offset:1024 sc1
s_waitcnt vmcnt(12)
v_mfma_f32_16x16x32_bf16 v[32:35], v[168:171], v[88:91], v[32:35]
v_mfma_f32_16x16x32_bf16 v[36:39], v[168:171], v[92:95], v[36:39]
v_mfma_f32_16x16x32_bf16 v[40:43], v[168:171], v[96:99], v[40:43]
buffer_load_dwordx4 v[148:151], v10, s[32:35], s63 offen offset:0 sc1
buffer_load_dwordx4 v[152:155], v10, s[32:35], s63 offen offset:512 sc1
buffer_load_dwordx4 v[156:159], v10, s[32:35], s63 offen offset:1024 sc1
s_waitcnt vmcnt(12)
v_mfma_f32_16x16x32_bf16 v[32:35], v[172:175], v[100:103], v[32:35]
v_mfma_f32_16x16x32_bf16 v[36:39], v[172:175], v[104:107], v[36:39]
v_mfma_f32_16x16x32_bf16 v[40:43], v[172:175], v[108:111], v[40:43]
s_waitcnt vmcnt(9)
v_mfma_f32_16x16x32_bf16 v[32:35], v[176:179], v[112:115], v[32:35]
v_mfma_f32_16x16x32_bf16 v[36:39], v[176:179], v[116:119], v[36:39]
v_mfma_f32_16x16x32_bf16 v[40:43], v[176:179], v[120:123], v[40:43]
s_waitcnt vmcnt(6)
v_mfma_f32_16x16x32_bf16 v[32:35], v[180:183], v[124:127], v[32:35]
v_mfma_f32_16x16x32_bf16 v[36:39], v[180:183], v[128:131], v[36:39]
v_mfma_f32_16x16x32_bf16 v[40:43], v[180:183], v[132:135], v[40:43]
s_waitcnt vmcnt(3)
v_mfma_f32_16x16x32_bf16 v[32:35], v[184:187], v[136:139], v[32:35]
v_mfma_f32_16x16x32_bf16 v[36:39], v[184:187], v[140:143], v[36:39]
v_mfma_f32_16x16x32_bf16 v[40:43], v[184:187], v[144:147], v[40:43]
s_waitcnt vmcnt(0)
v_mfma_f32_16x16x32_bf16 v[32:35], v[188:191], v[148:151], v[32:35]
v_mfma_f32_16x16x32_bf16 v[36:39], v[188:191], v[152:155], v[36:39]
v_mfma_f32_16x16x32_bf16 v[40:43], v[188:191], v[156:159], v[40:43]
s_mov_b64 exec, 0x101
buffer_store_dwordx4 v[4:7], v12, s[32:35], s48 offen offset:768 sc1
s_mov_b64 exec, -1
s_nop 3
v_cvt_pk_bf16_f32 v44, v32, v33
v_cvt_pk_bf16_f32 v45, v36, v37
v_cvt_pk_bf16_f32 v46, v40, v41
s_mov_b32 exec_lo, 0
v_cvt_pk_bf16_f32 v44, v34, v35
v_cvt_pk_bf16_f32 v45, v38, v39
v_cvt_pk_bf16_f32 v46, v42, v43
s_mov_b32 exec_lo, -1
buffer_store_dword v44, v18, s[32:35], s48 offen offset:0 sc1
buffer_store_dword v45, v18, s[32:35], s48 offen offset:256 sc1
buffer_store_dword v46, v18, s[32:35], s48 offen offset:512 sc1
s_endpgm
K_x:
s_mov_b32 s4, s3
v_and_b32 v76, 63, v0
v_mov_b32 v62, v0
v_lshlrev_b32 v76, 4, v76
s_mul_i32 s42, s4, 49152
s_add_u32 s42, s42, 24576
s_lshl_b32 s41, s36, 8
s_lshl_b32 s7, s4, 7
s_add_u32 s41, s41, s7
s_add_u32 s41, s41, 2097152
s_lshl_b32 s6, s4, 2
s_add_u32 s6, s6, 161920
v_mov_b32 v81, s6
v_and_b32 v64, 15, v0
v_bfe_u32 v65, v0, 4, 2
v_and_b32 v66, 3, v64
v_lshlrev_b32 v66, 2, v66
v_bfe_u32 v67, v64, 2, 1
v_lshl_add_u32 v66, v67, 1, v66
v_xor_b32 v66, v66, v65
v_mul_u32_u24 v48, 768, v64
v_lshl_add_u32 v48, v66, 4, v48
v_lshrrev_b32 v68, 1, v64
v_and_b32 v66, 3, v68
v_lshlrev_b32 v66, 2, v66
v_bfe_u32 v67, v68, 2, 1
v_lshl_add_u32 v66, v67, 1, v66
v_xor_b32 v66, v66, v65
v_mul_u32_u24 v52, 768, v68
v_lshl_add_u32 v52, v66, 4, v52
v_add_u32 v52, 24576, v52
v_xor_b32 v49, 64, v48
v_xor_b32 v53, 64, v52
v_xor_b32 v50, 128, v48
v_xor_b32 v54, 128, v52
v_xor_b32 v51, 192, v48
v_xor_b32 v55, 192, v52
s_lshl_b32 s6, s4, 4
v_add_u32 v66, s6, v64
v_lshlrev_b32 v56, 9, v65
v_lshl_add_u32 v56, v66, 4, v56
v_add_u32 v56, 153600, v56
v_lshrrev_b32 v67, 1, v65
v_lshlrev_b32 v57, 8, v67
v_lshl_add_u32 v57, v66, 3, v57
v_and_b32 v67, 1, v65
v_lshl_add_u32 v57, v67, 2, v57
v_add_u32 v57, 155648, v57
s_lshl_b32 s6, s4, 2
s_add_u32 s6, s6, 156288
v_mov_b32 v58, s6
v_lshlrev_b32 v60, 2, v64
s_mul_i32 s6, s4, 60
s_sub_u32 s6, s6, 128
v_add_u32 v60, s6, v60
v_mov_b32 v59, 161792
v_mov_b32 v37, 1
v_mov_b32 v31, 0
v_mov_b32 v0, 0
v_mov_b32 v1, 0
v_mov_b32 v2, 0
v_mov_b32 v3, 0
s_mov_b32 s21, -1.0
s_mov_b32 s22, 0xff800000
s_mov_b32 s20, 0
s_mov_b32 s19, 0
s_mov_b32 s23, 1
s_barrier
s_mov_b32 s30, 2097152
W45:
ds_read_b32 v78, v59 offset:64
s_sub_u32 s30, s30, 1
s_cselect_b32 s25, 0, 1
s_waitcnt lgkmcnt(0)
v_cmp_gt_u32 vcc, s25, v78
s_cbranch_vccz W45x
s_sleep 1
s_branch W45
W45x:
s_lshl_b32 s6, s36, 7
s_add_u32 s24, s6, 12288
s_cmp_ge_u32 s24, 24576
s_cselect_b32 s25, 24576, 0
s_sub_u32 s24, s24, s25
s_add_u32 s6, s6, s42
s_add_u32 s7, s24, s42
s_mov_b32 s30, 64
CA_bell:
s_load_dword s24, s[54:55], s6 glc
s_load_dword s25, s[54:55], s7 glc
s_sub_u32 s30, s30, 1
s_cbranch_scc1 CA_rang
s_waitcnt lgkmcnt(0)
s_max_u32 s24, s24, s25
s_cmp_eq_u32 s24, -1
s_cbranch_scc1 CA_bell
CA_rang:
s_waitcnt lgkmcnt(0)
ds_write_b32 v81, v37
s_mov_b32 s30, 2097152
CA_poll:
s_mov_b32 s6, s42
buffer_load_dwordx4 v[160:163], v76, s[32:35], s6 offen offset:0 sc1
buffer_load_dwordx4 v[164:167], v76, s[32:35], s6 offen offset:1024 sc1
buffer_load_dwordx4 v[168:171], v76, s[32:35], s6 offen offset:2048 sc1
buffer_load_dwordx4 v[172:175], v76, s[32:35], s6 offen offset:3072 sc1
s_add_u32 s6, s6, 4096
buffer_load_dwordx4 v[176:179], v76, s[32:35], s6 offen offset:0 sc1
buffer_load_dwordx4 v[180:183], v76, s[32:35], s6 offen offset:1024 sc1
buffer_load_dwordx4 v[184:187], v76, s[32:35], s6 offen offset:2048 sc1
buffer_load_dwordx4 v[188:191], v76, s[32:35], s6 offen offset:3072 sc1
s_add_u32 s6, s6, 4096
buffer_load_dwordx4 v[192:195], v76, s[32:35], s6 offen offset:0 sc1
buffer_load_dwordx4 v[196:199], v76, s[32:35], s6 offen offset:1024 sc1
buffer_load_dwordx4 v[200:203], v76, s[32:35], s6 offen offset:2048 sc1
buffer_load_dwordx4 v[204:207], v76, s[32:35], s6 offen offset:3072 sc1
s_add_u32 s6, s6, 4096
buffer_load_dwordx4 v[208:211], v76, s[32:35], s6 offen offset:0 sc1
buffer_load_dwordx4 v[212:215], v76, s[32:35], s6 offen offset:1024 sc1
buffer_load_dwordx4 v[216:219], v76, s[32:35], s6 offen offset:2048 sc1
buffer_load_dwordx4 v[220:223], v76, s[32:35], s6 offen offset:3072 sc1
s_add_u32 s6, s6, 4096
buffer_load_dwordx4 v[224:227], v76, s[32:35], s6 offen offset:0 sc1
buffer_load_dwordx4 v[228:231], v76, s[32:35], s6 offen offset:1024 sc1
buffer_load_dwordx4 v[232:235], v76, s[32:35], s6 offen offset:2048 sc1
buffer_load_dwordx4 v[236:239], v76, s[32:35], s6 offen offset:3072 sc1
s_add_u32 s6, s6, 4096
buffer_load_dwordx4 v[240:243], v76, s[32:35], s6 offen offset:0 sc1
buffer_load_dwordx4 v[244:247], v76, s[32:35], s6 offen offset:1024 sc1
buffer_load_dwordx4 v[248:251], v76, s[32:35], s6 offen offset:2048 sc1
buffer_load_dwordx4 v[252:255], v76, s[32:35], s6 offen offset:3072 sc1
s_add_u32 s6, s6, 4096
ds_write_b32 v81, v81
s_sub_u32 s30, s30, 1
s_cselect_b32 s25, 0, -1
v_mov_b32 v78, 0
s_waitcnt vmcnt(20)
v_max3_u32 v78, v78, v160, v161
v_max3_u32 v78, v78, v162, v163
v_max3_u32 v78, v78, v164, v165
v_max3_u32 v78, v78, v166, v167
v_max3_u32 v78, v78, v168, v169
v_max3_u32 v78, v78, v170, v171
v_max3_u32 v78, v78, v172, v173
v_max3_u32 v78, v78, v174, v175
s_waitcnt vmcnt(16)
v_max3_u32 v78, v78, v176, v177
v_max3_u32 v78, v78, v178, v179
v_max3_u32 v78, v78, v180, v181
v_max3_u32 v78, v78, v182, v183
v_max3_u32 v78, v78, v184, v185
v_max3_u32 v78, v78, v186, v187
v_max3_u32 v78, v78, v188, v189
v_max3_u32 v78, v78, v190, v191
s_waitcnt vmcnt(12)
v_max3_u32 v78, v78, v192, v193
v_max3_u32 v78, v78, v194, v195
v_max3_u32 v78, v78, v196, v197
v_max3_u32 v78, v78, v198, v199
v_max3_u32 v78, v78, v200, v201
v_max3_u32 v78, v78, v202, v203
v_max3_u32 v78, v78, v204, v205
v_max3_u32 v78, v78, v206, v207
s_waitcnt vmcnt(8)
v_max3_u32 v78, v78, v208, v209
v_max3_u32 v78, v78, v210, v211
v_max3_u32 v78, v78, v212, v213
v_max3_u32 v78, v78, v214, v215
v_max3_u32 v78, v78, v216, v217
v_max3_u32 v78, v78, v218, v219
v_max3_u32 v78, v78, v220, v221
v_max3_u32 v78, v78, v222, v223
s_waitcnt vmcnt(4)
v_max3_u32 v78, v78, v224, v225
v_max3_u32 v78, v78, v226, v227
v_max3_u32 v78, v78, v228, v229
v_max3_u32 v78, v78, v230, v231
v_max3_u32 v78, v78, v232, v233
v_max3_u32 v78, v78, v234, v235
v_max3_u32 v78, v78, v236, v237
v_max3_u32 v78, v78, v238, v239
s_waitcnt vmcnt(0)
v_max3_u32 v78, v78, v240, v241
v_max3_u32 v78, v78, v242, v243
v_max3_u32 v78, v78, v244, v245
v_max3_u32 v78, v78, v246, v247
v_max3_u32 v78, v78, v248, v249
v_max3_u32 v78, v78, v250, v251
v_max3_u32 v78, v78, v252, v253
v_max3_u32 v78, v78, v254, v255
v_cmp_eq_u32 vcc, -1, v78
s_and_b32 vcc_lo, vcc_lo, s25
s_and_b32 vcc_hi, vcc_hi, s25
s_cmp_lg_u64 vcc, 0
s_cbranch_scc1 CA_poll
s_mov_b32 s26, 30720
s_mov_b32 s27, 4294844416
s_mov_b32 s16, 2704
s_mov_b32 s17, 4294961888
s_branch X_spin
.p2align 6
X_top:
s_waitcnt lgkmcnt(5)
v_mfma_f32_16x16x32_bf16 v[8:11], v[64:67], v[160:163], v[4:7]
ds_read_b128 v[96:99], v48 offset:256
s_add_u32 s20, s20, 1
v_mfma_f32_16x16x32_bf16 v[12:15], v[68:71], v[160:163], v[4:7]
ds_read_b128 v[100:103], v48 offset:12544
s_cmp_eq_u32 s20, 5
v_mfma_f32_16x16x32_bf16 v[8:11], v[72:75], v[164:167], v[8:11]
ds_read_b128 v[104:107], v49 offset:256
s_cselect_b32 s24, s27, s26
s_waitcnt lgkmcnt(5)
v_mfma_f32_16x16x32_bf16 v[12:15], v[76:79], v[164:167], v[12:15]
ds_read_b128 v[108:111], v49 offset:12544
s_cselect_b32 s20, 0, s20
v_mfma_f32_16x16x32_bf16 v[8:11], v[80:83], v[168:171], v[8:11]
ds_read_b128 v[64:67], v50 offset:256
s_add_u32 s19, s19, 1
v_mfma_f32_16x16x32_bf16 v[12:15], v[84:87], v[168:171], v[12:15]
ds_read_b128 v[68:71], v50 offset:12544
s_cmp_eq_u32 s19, 3
s_waitcnt lgkmcnt(5)
v_mfma_f32_16x16x32_bf16 v[8:11], v[88:91], v[172:175], v[8:11]
ds_read_b128 v[72:75], v51 offset:256
s_cselect_b32 s18, s17, s16
v_mfma_f32_16x16x32_bf16 v[12:15], v[92:95], v[172:175], v[12:15]
ds_read_b128 v[76:79], v51 offset:12544
s_cselect_b32 s19, 0, s19
v_mfma_f32_16x16x32_bf16 v[8:11], v[96:99], v[176:179], v[8:11]
ds_read_b128 v[80:83], v48 offset:512
ds_read_b64 v[40:41], v59
ds_read_b128 v[42:45], v59 offset:16
s_add_u32 s23, s23, 1
s_waitcnt lgkmcnt(7)
v_mfma_f32_16x16x32_bf16 v[12:15], v[100:103], v[176:179], v[12:15]
ds_read_b128 v[84:87], v48 offset:12800
v_add_u32 v52, s24, v52
v_mfma_f32_16x16x32_bf16 v[8:11], v[104:107], v[180:183], v[8:11]
ds_read_b128 v[88:91], v49 offset:512
v_add_u32 v53, s24, v53
v_mfma_f32_16x16x32_bf16 v[12:15], v[108:111], v[180:183], v[12:15]
ds_read_b128 v[92:95], v49 offset:12800
v_add_u32 v54, s24, v54
s_waitcnt lgkmcnt(7)
v_mfma_f32_16x16x32_bf16 v[8:11], v[64:67], v[184:187], v[8:11]
ds_read_b128 v[96:99], v50 offset:512
v_add_u32 v55, s24, v55
v_mfma_f32_16x16x32_bf16 v[12:15], v[68:71], v[184:187], v[12:15]
ds_read_b128 v[100:103], v50 offset:12800
s_waitcnt lgkmcnt(5)
v_min3_u32 v42, v42, v43, v44
v_mfma_f32_16x16x32_bf16 v[8:11], v[72:75], v[188:191], v[8:11]
ds_read_b128 v[104:107], v51 offset:512
v_min3_u32 v40, v40, v42, v45
v_cmp_gt_u32 vcc, s23, v40
s_waitcnt lgkmcnt(5)
v_mfma_f32_16x16x32_bf16 v[12:15], v[76:79], v[188:191], v[12:15]
ds_read_b128 v[108:111], v51 offset:12800
s_cbranch_vccnz X_slow
v_mfma_f32_16x16x32_bf16 v[8:11], v[80:83], v[192:195], v[8:11]
ds_read_b128 v[64:67], v52 offset:0
v_add_u32 v48, s24, v48
v_mfma_f32_16x16x32_bf16 v[12:15], v[84:87], v[192:195], v[12:15]
ds_read_b128 v[68:71], v53 offset:0
v_add_u32 v49, s24, v49
s_waitcnt lgkmcnt(5)
v_mfma_f32_16x16x32_bf16 v[8:11], v[88:91], v[196:199], v[8:11]
ds_read_b128 v[72:75], v54 offset:0
v_add_u32 v50, s24, v50
v_mfma_f32_16x16x32_bf16 v[12:15], v[92:95], v[196:199], v[12:15]
ds_read_b128 v[76:79], v55 offset:0
v_add_u32 v51, s24, v51
v_mfma_f32_16x16x32_bf16 v[8:11], v[96:99], v[200:203], v[8:11]
ds_read_b128 v[80:83], v52 offset:256
s_waitcnt lgkmcnt(5)
v_mfma_f32_16x16x32_bf16 v[12:15], v[100:103], v[200:203], v[12:15]
ds_read_b128 v[84:87], v53 offset:256
v_mfma_f32_16x16x32_bf16 v[8:11], v[104:107], v[204:207], v[8:11]
ds_read_b128 v[88:91], v54 offset:256
v_mfma_f32_16x16x32_bf16 v[12:15], v[108:111], v[204:207], v[12:15]
ds_read_b128 v[92:95], v55 offset:256
s_waitcnt lgkmcnt(5)
v_mfma_f32_16x16x32_bf16 v[4:7], v[64:67], v[208:211], v[0:3]
ds_read_b128 v[96:99], v52 offset:512
v_mfma_f32_16x16x32_bf16 v[4:7], v[68:71], v[212:215], v[4:7]
ds_read_b128 v[100:103], v53 offset:512
v_mfma_f32_16x16x32_bf16 v[4:7], v[72:75], v[216:219], v[4:7]
ds_read_b128 v[104:107], v54 offset:512
s_waitcnt lgkmcnt(5)
v_mfma_f32_16x16x32_bf16 v[4:7], v[76:79], v[220:223], v[4:7]
ds_read_b128 v[108:111], v55 offset:512
v_exp_f32 v16, v8
v_exp_f32 v17, v9
v_mfma_f32_16x16x32_bf16 v[4:7], v[80:83], v[224:227], v[4:7]
ds_read_b128 v[64:67], v48 offset:0
v_exp_f32 v18, v10
v_exp_f32 v19, v11
v_mfma_f32_16x16x32_bf16 v[4:7], v[84:87], v[228:231], v[4:7]
ds_read_b128 v[68:71], v48 offset:12288
v_exp_f32 v20, v12
v_exp_f32 v21, v13
s_waitcnt lgkmcnt(5)
v_mfma_f32_16x16x32_bf16 v[4:7], v[88:91], v[232:235], v[4:7]
ds_read_b128 v[72:75], v49 offset:0
v_exp_f32 v22, v14
v_exp_f32 v23, v15
v_mfma_f32_16x16x32_bf16 v[4:7], v[92:95], v[236:239], v[4:7]
ds_read_b128 v[76:79], v49 offset:12288
v_add_f32 v24, v16, v20
v_add_f32 v25, v17, v21
v_add_f32 v26, v18, v22
v_add_f32 v27, v19, v23
v_mfma_f32_16x16x32_bf16 v[4:7], v[96:99], v[240:243], v[4:7]
ds_read_b128 v[80:83], v50 offset:0
v_add_f32 v28, v24, v25
v_add_f32 v29, v26, v27
v_add_f32 v30, v28, v29
v_cmp_lt_f32 vcc, s21, v30
s_waitcnt lgkmcnt(5)
v_mfma_f32_16x16x32_bf16 v[4:7], v[100:103], v[244:247], v[4:7]
ds_read_b128 v[84:87], v50 offset:12288
v_cvt_pk_bf16_f32 v32, v16, v17
v_cvt_pk_bf16_f32 v33, v18, v19
v_cvt_pk_bf16_f32 v34, v20, v21
v_cvt_pk_bf16_f32 v35, v22, v23
v_cvt_pk_bf16_f32 v36, v28, v29
s_cbranch_vccnz X_fix
v_mfma_f32_16x16x32_bf16 v[4:7], v[104:107], v[248:251], v[4:7]
ds_write_b128 v56, v[32:35]
ds_write_b32 v57, v36
ds_read_b128 v[88:91], v51 offset:0
v_mfma_f32_16x16x32_bf16 v[4:7], v[108:111], v[252:255], v[4:7]
ds_write_b32 v58, v37
ds_read_b128 v[92:95], v51 offset:12288
v_add_f32 v31, v31, v30
v_add_u32 v56, s18, v56
v_add_u32 v57, s18, v57
v_add_u32 v58, s18, v58
v_add_u32 v37, 1, v37
s_branch X_top
X_slow:
v_mfma_f32_16x16x32_bf16 v[8:11], v[80:83], v[192:195], v[8:11]
v_add_u32 v48, s24, v48
v_mfma_f32_16x16x32_bf16 v[12:15], v[84:87], v[192:195], v[12:15]
v_add_u32 v49, s24, v49
s_waitcnt lgkmcnt(3)
v_mfma_f32_16x16x32_bf16 v[8:11], v[88:91], v[196:199], v[8:11]
v_add_u32 v50, s24, v50
v_mfma_f32_16x16x32_bf16 v[12:15], v[92:95], v[196:199], v[12:15]
v_add_u32 v51, s24, v51
v_mfma_f32_16x16x32_bf16 v[8:11], v[96:99], v[200:203], v[8:11]
s_waitcnt lgkmcnt(0)
v_mfma_f32_16x16x32_bf16 v[12:15], v[100:103], v[200:203], v[12:15]
v_mfma_f32_16x16x32_bf16 v[8:11], v[104:107], v[204:207], v[8:11]
v_mfma_f32_16x16x32_bf16 v[12:15], v[108:111], v[204:207], v[12:15]
s_nop 6
X_sm:
v_exp_f32 v16, v8
v_exp_f32 v17, v9
v_exp_f32 v18, v10
v_exp_f32 v19, v11
v_exp_f32 v20, v12
v_exp_f32 v21, v13
v_exp_f32 v22, v14
v_exp_f32 v23, v15
v_add_f32 v24, v16, v20
v_add_f32 v25, v17, v21
v_add_f32 v26, v18, v22
v_add_f32 v27, v19, v23
v_add_f32 v28, v24, v25
v_add_f32 v29, v26, v27
v_add_f32 v30, v28, v29
v_cmp_lt_f32 vcc, s21, v30
v_cvt_pk_bf16_f32 v32, v16, v17
v_cvt_pk_bf16_f32 v33, v18, v19
v_cvt_pk_bf16_f32 v34, v20, v21
v_cvt_pk_bf16_f32 v35, v22, v23
v_cvt_pk_bf16_f32 v36, v28, v29
s_cbranch_vccnz X_fix
ds_write_b128 v56, v[32:35]
ds_write_b32 v57, v36
ds_write_b32 v58, v37
v_add_f32 v31, v31, v30
v_add_u32 v56, s18, v56
v_add_u32 v57, s18, v57
v_add_u32 v58, s18, v58
v_add_u32 v37, 1, v37
X_spin:
s_mov_b32 s30, 2097152
s_branch X_sp1
X_sp0:
s_sleep 1
X_sp1:
ds_read_b64 v[40:41], v59
ds_read_b128 v[42:45], v59 offset:16
s_sub_u32 s30, s30, 1
s_cbranch_scc1 X_exit
s_waitcnt lgkmcnt(0)
v_cmp_gt_u32 s[28:29], s23, v41
v_min3_u32 v42, v42, v43, v44
v_min3_u32 v40, v40, v42, v45
v_cmp_gt_u32 vcc, s23, v40
s_cmp_lg_u64 s[28:29], 0
s_cbranch_scc1 X_exit
s_cbranch_vccnz X_tl
ds_read_b128 v[64:67], v52 offset:0
ds_read_b128 v[68:71], v53 offset:0
ds_read_b128 v[72:75], v54 offset:0
ds_read_b128 v[76:79], v55 offset:0
ds_read_b128 v[80:83], v52 offset:256
ds_read_b128 v[84:87], v53 offset:256
ds_read_b128 v[88:91], v54 offset:256
ds_read_b128 v[92:95], v55 offset:256
s_waitcnt lgkmcnt(5)
v_mfma_f32_16x16x32_bf16 v[4:7], v[64:67], v[208:211], v[0:3]
ds_read_b128 v[96:99], v52 offset:512
v_mfma_f32_16x16x32_bf16 v[4:7], v[68:71], v[212:215], v[4:7]
ds_read_b128 v[100:103], v53 offset:512
v_mfma_f32_16x16x32_bf16 v[4:7], v[72:75], v[216:219], v[4:7]
ds_read_b128 v[104:107], v54 offset:512
s_waitcnt lgkmcnt(5)
v_mfma_f32_16x16x32_bf16 v[4:7], v[76:79], v[220:223], v[4:7]
ds_read_b128 v[108:111], v55 offset:512
v_mfma_f32_16x16x32_bf16 v[4:7], v[80:83], v[224:227], v[4:7]
ds_read_b128 v[64:67], v48 offset:0
v_mfma_f32_16x16x32_bf16 v[4:7], v[84:87], v[228:231], v[4:7]
ds_read_b128 v[68:71], v48 offset:12288
s_waitcnt lgkmcnt(5)
v_mfma_f32_16x16x32_bf16 v[4:7], v[88:91], v[232:235], v[4:7]
ds_read_b128 v[72:75], v49 offset:0
v_mfma_f32_16x16x32_bf16 v[4:7], v[92:95], v[236:239], v[4:7]
ds_read_b128 v[76:79], v49 offset:12288
v_mfma_f32_16x16x32_bf16 v[4:7], v[96:99], v[240:243], v[4:7]
ds_read_b128 v[80:83], v50 offset:0
s_waitcnt lgkmcnt(5)
v_mfma_f32_16x16x32_bf16 v[4:7], v[100:103], v[244:247], v[4:7]
ds_read_b128 v[84:87], v50 offset:12288
v_mfma_f32_16x16x32_bf16 v[4:7], v[104:107], v[248:251], v[4:7]
ds_read_b128 v[88:91], v51 offset:0
v_mfma_f32_16x16x32_bf16 v[4:7], v[108:111], v[252:255], v[4:7]
ds_read_b128 v[92:95], v51 offset:12288
s_branch X_top
X_tl:
v_min_u32 v42, v42, v45
v_cmp_ne_u32 s[28:29], s23, v41
v_cmp_gt_u32 vcc, s23, v42
s_or_b64 vcc, vcc, s[28:29]
s_cbranch_scc1 X_sp0
XT_w81:
ds_read_b32 v40, v59 offset:8
s_sub_u32 s30, s30, 1
s_cbranch_scc1 X_exit
s_waitcnt lgkmcnt(0)
v_cmp_gt_u32 vcc, 1, v40
s_cbranch_vccnz XT_w81
ds_read_b128 v[64:67], v52 offset:0
ds_read_b128 v[68:71], v53 offset:0
ds_read_b128 v[72:75], v54 offset:0
ds_read_b128 v[76:79], v55 offset:0
ds_read_b128 v[80:83], v52 offset:256
ds_read_b128 v[84:87], v53 offset:256
s_waitcnt lgkmcnt(4)
v_mfma_f32_16x16x32_bf16 v[4:7], v[64:67], v[208:211], v[0:3]
ds_read_b128 v[88:91], v54 offset:256
v_mfma_f32_16x16x32_bf16 v[4:7], v[68:71], v[212:215], v[4:7]
ds_read_b128 v[92:95], v55 offset:256
s_waitcnt lgkmcnt(4)
v_mfma_f32_16x16x32_bf16 v[4:7], v[72:75], v[216:219], v[4:7]
ds_read_b128 v[96:99], v52 offset:512
v_mfma_f32_16x16x32_bf16 v[4:7], v[76:79], v[220:223], v[4:7]
ds_read_b128 v[100:103], v53 offset:512
s_waitcnt lgkmcnt(4)
v_mfma_f32_16x16x32_bf16 v[4:7], v[80:83], v[224:227], v[4:7]
ds_read_b128 v[104:107], v54 offset:512
v_mfma_f32_16x16x32_bf16 v[4:7], v[84:87], v[228:231], v[4:7]
ds_read_b128 v[108:111], v55 offset:512
s_waitcnt lgkmcnt(4)
v_mfma_f32_16x16x32_bf16 v[4:7], v[88:91], v[232:235], v[4:7]
v_mfma_f32_16x16x32_bf16 v[4:7], v[92:95], v[236:239], v[4:7]
s_waitcnt lgkmcnt(2)
v_mfma_f32_16x16x32_bf16 v[4:7], v[96:99], v[240:243], v[4:7]
v_mfma_f32_16x16x32_bf16 v[4:7], v[100:103], v[244:247], v[4:7]
s_waitcnt lgkmcnt(0)
v_mfma_f32_16x16x32_bf16 v[4:7], v[104:107], v[248:251], v[4:7]
v_mfma_f32_16x16x32_bf16 v[4:7], v[108:111], v[252:255], v[4:7]
XT_w82:
ds_read_b32 v40, v59 offset:8
s_sub_u32 s30, s30, 1
s_cbranch_scc1 X_exit
s_waitcnt lgkmcnt(0)
v_cmp_gt_u32 vcc, 2, v40
s_cbranch_vccnz XT_w82
ds_read_b128 v[64:67], v48 offset:0
ds_read_b128 v[68:71], v49 offset:0
ds_read_b128 v[72:75], v50 offset:0
ds_read_b128 v[76:79], v51 offset:0
ds_read_b128 v[80:83], v48 offset:256
ds_read_b128 v[84:87], v49 offset:256
s_waitcnt lgkmcnt(4)
v_mfma_f32_16x16x32_bf16 v[8:11], v[64:67], v[160:163], v[4:7]
ds_read_b128 v[88:91], v50 offset:256
v_mfma_f32_16x16x32_bf16 v[8:11], v[68:71], v[164:167], v[8:11]
ds_read_b128 v[92:95], v51 offset:256
s_waitcnt lgkmcnt(4)
v_mfma_f32_16x16x32_bf16 v[8:11], v[72:75], v[168:171], v[8:11]
ds_read_b128 v[96:99], v48 offset:512
v_mfma_f32_16x16x32_bf16 v[8:11], v[76:79], v[172:175], v[8:11]
ds_read_b128 v[100:103], v49 offset:512
s_waitcnt lgkmcnt(4)
v_mfma_f32_16x16x32_bf16 v[8:11], v[80:83], v[176:179], v[8:11]
ds_read_b128 v[104:107], v50 offset:512
v_mfma_f32_16x16x32_bf16 v[8:11], v[84:87], v[180:183], v[8:11]
ds_read_b128 v[108:111], v51 offset:512
s_waitcnt lgkmcnt(4)
v_mfma_f32_16x16x32_bf16 v[8:11], v[88:91], v[184:187], v[8:11]
v_mfma_f32_16x16x32_bf16 v[8:11], v[92:95], v[188:191], v[8:11]
s_waitcnt lgkmcnt(2)
v_mfma_f32_16x16x32_bf16 v[8:11], v[96:99], v[192:195], v[8:11]
v_mfma_f32_16x16x32_bf16 v[8:11], v[100:103], v[196:199], v[8:11]
s_waitcnt lgkmcnt(0)
v_mfma_f32_16x16x32_bf16 v[8:11], v[104:107], v[200:203], v[8:11]
v_mfma_f32_16x16x32_bf16 v[8:11], v[108:111], v[204:207], v[8:11]
XT_w0s23:
ds_read_b32 v40, v59 offset:0
s_sub_u32 s30, s30, 1
s_cbranch_scc1 X_exit
s_waitcnt lgkmcnt(0)
v_cmp_gt_u32 vcc, s23, v40
s_cbranch_vccnz XT_w0s23
ds_read_b128 v[64:67], v48 offset:12288
ds_read_b128 v[68:71], v49 offset:12288
ds_read_b128 v[72:75], v50 offset:12288
ds_read_b128 v[76:79], v51 offset:12288
ds_read_b128 v[80:83], v48 offset:12544
ds_read_b128 v[84:87], v49 offset:12544
s_waitcnt lgkmcnt(4)
v_mfma_f32_16x16x32_bf16 v[12:15], v[64:67], v[160:163], v[4:7]
ds_read_b128 v[88:91], v50 offset:12544
v_mfma_f32_16x16x32_bf16 v[12:15], v[68:71], v[164:167], v[12:15]
ds_read_b128 v[92:95], v51 offset:12544
s_waitcnt lgkmcnt(4)
v_mfma_f32_16x16x32_bf16 v[12:15], v[72:75], v[168:171], v[12:15]
ds_read_b128 v[96:99], v48 offset:12800
v_mfma_f32_16x16x32_bf16 v[12:15], v[76:79], v[172:175], v[12:15]
ds_read_b128 v[100:103], v49 offset:12800
s_waitcnt lgkmcnt(4)
v_mfma_f32_16x16x32_bf16 v[12:15], v[80:83], v[176:179], v[12:15]
ds_read_b128 v[104:107], v50 offset:12800
v_mfma_f32_16x16x32_bf16 v[12:15], v[84:87], v[180:183], v[12:15]
ds_read_b128 v[108:111], v51 offset:12800
s_waitcnt lgkmcnt(4)
v_mfma_f32_16x16x32_bf16 v[12:15], v[88:91], v[184:187], v[12:15]
v_mfma_f32_16x16x32_bf16 v[12:15], v[92:95], v[188:191], v[12:15]
s_waitcnt lgkmcnt(2)
v_mfma_f32_16x16x32_bf16 v[12:15], v[96:99], v[192:195], v[12:15]
v_mfma_f32_16x16x32_bf16 v[12:15], v[100:103], v[196:199], v[12:15]
s_waitcnt lgkmcnt(0)
v_mfma_f32_16x16x32_bf16 v[12:15], v[104:107], v[200:203], v[12:15]
v_mfma_f32_16x16x32_bf16 v[12:15], v[108:111], v[204:207], v[12:15]
s_add_u32 s23, s23, 1
s_nop 1
s_branch X_sm
X_fix:
v_max3_f32 v30, v8, v9, v10
v_max3_f32 v30, v30, v11, v12
v_max3_f32 v30, v30, v13, v14
v_max_f32 v30, v30, v15
v_mov_b32 v24, v30
s_nop 1
v_permlane32_swap_b32 v24, v30
s_nop 0
v_max_f32 v30, v30, v24
v_mov_b32 v24, v30
s_nop 1
v_permlane16_swap_b32 v24, v30
s_nop 0
v_max_f32 v30, v30, v24
v_max_f32 v30, s22, v30
s_mov_b32 s21, 0x4b800000
s_mov_b32 s22, 0
v_sub_f32 v8, v8, v30
v_sub_f32 v9, v9, v30
v_sub_f32 v10, v10, v30
v_sub_f32 v11, v11, v30
v_sub_f32 v12, v12, v30
v_sub_f32 v13, v13, v30
v_sub_f32 v14, v14, v30
v_sub_f32 v15, v15, v30
v_sub_f32 v0, v0, v30
v_sub_f32 v1, v1, v30
v_sub_f32 v2, v2, v30
v_sub_f32 v3, v3, v30
s_cmp_eq_u32 s23, 2
s_cbranch_scc1 X_sm
v_sub_f32 v30, 0, v30
v_exp_f32 v30, v30
v_add_u32 v24, v60, v58
v_mul_f32 v31, v31, v30
ds_write_b32 v24, v30
ds_write_b32 v58, v37 offset:8
s_branch X_sm
X_exit:
s_mov_b32 s30, 2097152
W46:
ds_read_b32 v78, v59 offset:68
s_sub_u32 s30, s30, 1
s_cselect_b32 s25, 0, 1
s_waitcnt lgkmcnt(0)
v_cmp_gt_u32 vcc, s25, v78
s_cbranch_vccnz W46
v_readfirstlane_b32 s45, v78
v_mov_b32 v30, v31
s_nop 1
v_permlane32_swap_b32 v30, v31
s_nop 0
v_add_f32 v31, v31, v30
v_mov_b32 v30, v31
s_nop 1
v_permlane16_swap_b32 v30, v31
s_nop 0
v_add_f32 v31, v31, v30
v_sub_f32 v30, 0, v0
v_and_b32 v78, 15, v62
v_lshlrev_b32 v78, 3, v78
s_mov_b64 exec, 0xffff
s_cmp_eq_u32 s45, 2
s_cbranch_scc0 T47g
buffer_store_dwordx2 v[30:31], v78, s[32:35], s41 offen
T47r:
s_mov_b64 exec, -1
s_endpgm
T47g:
buffer_store_dwordx2 v[30:31], v78, s[32:35], s41 offen sc1
s_branch T47r
K_y:
s_and_b32 s4, s3, 1
s_lshr_b32 s5, s3, 2
v_and_b32 v64, 63, v0
v_lshrrev_b32 v65, 5, v64
v_bfe_u32 v66, v64, 4, 1
v_bfe_u32 v67, v64, 2, 2
v_and_b32 v68, 3, v64
v_lshl_add_u32 v69, v65, 2, v67
v_mul_u32_u24 v4, 768, v69
v_lshl_add_u32 v69, v67, 1, v65
v_xor_b32 v69, v69, v66
s_lshl_b32 s6, s4, 2
v_xor_b32 v69, s6, v69
v_lshl_add_u32 v4, v69, 5, v4
v_lshl_add_u32 v4, v68, 3, v4
s_mul_i32 s6, s5, 24576
v_add_u32 v4, s6, v4
v_xor_b32 v5, 64, v4
s_sub_u32 s6, 4, s5
v_lshlrev_b32 v20, s6, v64
s_mul_i32 s6, s5, 2048
s_add_u32 s6, s6, 153600
v_add_u32 v20, s6, v20
v_mov_b32 v21, 156288
v_mov_b32 v22, 161792
v_mov_b32 v23, 4
v_mov_b32 v27, 0
s_lshl_b32 s6, s5, 1
s_add_u32 s44, s6, s4
s_lshl_b32 s6, s44, 2
s_add_u32 s6, s6, 161808
v_mov_b32 v24, s6
v_lshlrev_b32 v25, 4, v65
v_subrev_u32 v25, 128, v25
v_mov_b32 v160, 0
v_mov_b32 v161, 0
v_mov_b32 v162, 0
v_mov_b32 v163, 0
v_mov_b32 v164, 0
v_mov_b32 v165, 0
v_mov_b32 v166, 0
v_mov_b32 v167, 0
v_mov_b32 v168, 0
v_mov_b32 v169, 0
v_mov_b32 v170, 0
v_mov_b32 v171, 0
v_mov_b32 v172, 0
v_mov_b32 v173, 0
v_mov_b32 v174, 0
v_mov_b32 v175, 0
v_mov_b32 v176, 0
v_mov_b32 v177, 0
v_mov_b32 v178, 0
v_mov_b32 v179, 0
v_mov_b32 v180, 0
v_mov_b32 v181, 0
v_mov_b32 v182, 0
v_mov_b32 v183, 0
v_mov_b32 v184, 0
v_mov_b32 v185, 0
v_mov_b32 v186, 0
v_mov_b32 v187, 0
v_mov_b32 v188, 0
v_mov_b32 v189, 0
v_mov_b32 v190, 0
v_mov_b32 v191, 0
v_mov_b32 v192, 0
v_mov_b32 v193, 0
v_mov_b32 v194, 0
v_mov_b32 v195, 0
v_mov_b32 v196, 0
v_mov_b32 v197, 0
v_mov_b32 v198, 0
v_mov_b32 v199, 0
v_mov_b32 v200, 0
v_mov_b32 v201, 0
v_mov_b32 v202, 0
v_mov_b32 v203, 0
v_mov_b32 v204, 0
v_mov_b32 v205, 0
v_mov_b32 v206, 0
v_mov_b32 v207, 0
v_mov_b32 v208, 0
v_mov_b32 v209, 0
v_mov_b32 v210, 0
v_mov_b32 v211, 0
v_mov_b32 v212, 0
v_mov_b32 v213, 0
v_mov_b32 v214, 0
v_mov_b32 v215, 0
v_mov_b32 v216, 0
v_mov_b32 v217, 0
v_mov_b32 v218, 0
v_mov_b32 v219, 0
v_mov_b32 v220, 0
v_mov_b32 v221, 0
v_mov_b32 v222, 0
v_mov_b32 v223, 0
v_mov_b32 v224, 0
v_mov_b32 v225, 0
v_mov_b32 v226, 0
v_mov_b32 v227, 0
v_mov_b32 v228, 0
v_mov_b32 v229, 0
v_mov_b32 v230, 0
v_mov_b32 v231, 0
v_mov_b32 v232, 0
v_mov_b32 v233, 0
v_mov_b32 v234, 0
v_mov_b32 v235, 0
v_mov_b32 v236, 0
v_mov_b32 v237, 0
v_mov_b32 v238, 0
v_mov_b32 v239, 0
v_mov_b32 v240, 0
v_mov_b32 v241, 0
v_mov_b32 v242, 0
v_mov_b32 v243, 0
v_mov_b32 v244, 0
v_mov_b32 v245, 0
v_mov_b32 v246, 0
v_mov_b32 v247, 0
v_mov_b32 v248, 0
v_mov_b32 v249, 0
v_mov_b32 v250, 0
v_mov_b32 v251, 0
v_mov_b32 v252, 0
v_mov_b32 v253, 0
v_mov_b32 v254, 0
v_mov_b32 v255, 0
s_mov_b32 s20, 0
s_mov_b32 s19, 0
s_mov_b32 s23, 1
s_lshl_b32 s40, s37, 5
s_add_u32 s40, s40, s44
s_mul_i32 s40, s40, 49152
s_mul_i32 s7, s38, 1536
s_add_u32 s40, s40, s7
s_add_u32 s40, s40, 3145728
s_lshl_b32 s41, s36, 7
s_lshl_b32 s7, s44, 2
s_add_u32 s41, s41, s7
s_add_u32 s41, s41, 2146304
s_mov_b32 s6, 196608
v_mul_lo_u32 v2, v65, s6
v_and_b32 v3, 31, v0
v_lshl_add_u32 v2, v3, 4, v2
s_barrier
s_mov_b32 s30, 2097152
W48:
ds_read_b32 v26, v22 offset:128
s_sub_u32 s30, s30, 1
s_cselect_b32 s25, 0, 1
s_waitcnt lgkmcnt(0)
v_cmp_gt_u32 vcc, s25, v26
s_cbranch_vccz W48x
s_sleep 4
s_branch W48
W48x:
s_cmp_eq_u32 s5, 0
s_cbranch_scc0 Y_lo
s_mov_b32 s26, 30720
s_mov_b32 s27, 4294844416
s_mov_b32 s16, 2704
s_mov_b32 s17, 4294961888
s_mov_b32 s30, 2097152
s_branch YH_top
.p2align 6
YH_top:
ds_read_b128 v[16:19], v21
ds_read_b128 v[8:11], v20
ds_read_b128 v[12:15], v20 offset:1024
ds_read_b64_tr_b16 v[64:65], v4 offset:0
ds_read_b64_tr_b16 v[66:67], v4 offset:12288
ds_read_b64_tr_b16 v[68:69], v5 offset:0
ds_read_b64_tr_b16 v[70:71], v5 offset:12288
ds_read_b64_tr_b16 v[72:73], v4 offset:256
ds_read_b64_tr_b16 v[74:75], v4 offset:12544
ds_read_b64_tr_b16 v[76:77], v5 offset:256
ds_read_b64_tr_b16 v[78:79], v5 offset:12544
s_waitcnt lgkmcnt(10)
v_min_u32 v16, v16, v17
v_max_u32 v17, v18, v19
v_cmp_gt_u32 s[28:29], s23, v16
v_cmp_eq_u32 vcc, s23, v17
s_or_b64 vcc, vcc, s[28:29]
s_cbranch_scc1 YH_fix
YH_go:
s_waitcnt lgkmcnt(6)
v_mfma_f32_32x32x16_bf16 v[160:175], v[8:11], v[64:67], v[160:175]
ds_read_b64_tr_b16 v[80:81], v4 offset:512
ds_read_b64_tr_b16 v[82:83], v4 offset:12800
s_add_u32 s20, s20, 1
s_cmp_eq_u32 s20, 5
s_waitcnt lgkmcnt(6)
v_mfma_f32_32x32x16_bf16 v[176:191], v[8:11], v[68:71], v[176:191]
ds_read_b64_tr_b16 v[84:85], v5 offset:512
ds_read_b64_tr_b16 v[86:87], v5 offset:12800
s_cselect_b32 s24, s27, s26
s_cselect_b32 s20, 0, s20
s_waitcnt lgkmcnt(6)
v_mfma_f32_32x32x16_bf16 v[192:207], v[8:11], v[72:75], v[192:207]
ds_read_b64_tr_b16 v[88:89], v4 offset:6144
ds_read_b64_tr_b16 v[90:91], v4 offset:18432
s_add_u32 s19, s19, 1
s_cmp_eq_u32 s19, 3
s_waitcnt lgkmcnt(6)
v_mfma_f32_32x32x16_bf16 v[208:223], v[8:11], v[76:79], v[208:223]
ds_read_b64_tr_b16 v[92:93], v5 offset:6144
ds_read_b64_tr_b16 v[94:95], v5 offset:18432
s_cselect_b32 s18, s17, s16
s_cselect_b32 s19, 0, s19
s_waitcnt lgkmcnt(6)
v_mfma_f32_32x32x16_bf16 v[224:239], v[8:11], v[80:83], v[224:239]
ds_read_b64_tr_b16 v[96:97], v4 offset:6400
ds_read_b64_tr_b16 v[98:99], v4 offset:18688
s_add_u32 s23, s23, 1
s_mov_b32 s30, 2097152
s_waitcnt lgkmcnt(6)
v_mfma_f32_32x32x16_bf16 v[240:255], v[8:11], v[84:87], v[240:255]
ds_read_b64_tr_b16 v[100:101], v5 offset:6400
ds_read_b64_tr_b16 v[102:103], v5 offset:18688
s_waitcnt lgkmcnt(6)
v_mfma_f32_32x32x16_bf16 v[160:175], v[12:15], v[88:91], v[160:175]
ds_read_b64_tr_b16 v[104:105], v4 offset:6656
ds_read_b64_tr_b16 v[106:107], v4 offset:18944
s_waitcnt lgkmcnt(6)
v_mfma_f32_32x32x16_bf16 v[176:191], v[12:15], v[92:95], v[176:191]
ds_read_b64_tr_b16 v[108:109], v5 offset:6656
ds_read_b64_tr_b16 v[110:111], v5 offset:18944
s_waitcnt lgkmcnt(6)
v_mfma_f32_32x32x16_bf16 v[192:207], v[12:15], v[96:99], v[192:207]
ds_read2_b32 v[26:27], v22 offset0:1 offset1:17
ds_write_b32 v24, v23
v_add_u32 v4, s24, v4
v_add_u32 v5, s24, v5
s_waitcnt lgkmcnt(6)
v_mfma_f32_32x32x16_bf16 v[208:223], v[12:15], v[100:103], v[208:223]
v_add_u32 v20, s18, v20
v_add_u32 v21, s18, v21
s_waitcnt lgkmcnt(4)
v_mfma_f32_32x32x16_bf16 v[224:239], v[12:15], v[104:107], v[224:239]
v_add_u32 v23, 1, v23
s_waitcnt lgkmcnt(2)
v_mfma_f32_32x32x16_bf16 v[240:255], v[12:15], v[108:111], v[240:255]
s_waitcnt lgkmcnt(1)
v_cmp_gt_u32 vcc, s23, v26
s_cbranch_vccz YH_top
s_branch Y_exit
YH_fix:
s_cmp_lg_u64 s[28:29], 0
s_cbranch_scc0 YH_resc
YH_sp:
ds_read_b64 v[16:17], v21
ds_read_b32 v18, v22 offset:4
s_sub_u32 s30, s30, 1
s_cbranch_scc1 Y_exit
s_waitcnt lgkmcnt(0)
v_min_u32 v16, v16, v17
v_cmp_gt_u32 s[28:29], s23, v18
v_cmp_gt_u32 vcc, s23, v16
s_cmp_lg_u64 s[28:29], 0
s_cbranch_scc1 Y_exit
s_cbranch_vccz YH_top
s_branch YH_sp
YH_resc:
v_add_u32 v28, v21, v25
v_cmp_eq_u32 s[28:29], s23, v18
v_cmp_eq_u32 vcc, s23, v19
ds_read_b128 v[32:35], v28 offset:0
ds_read_b128 v[36:39], v28 offset:32
ds_read_b128 v[40:43], v28 offset:64
ds_read_b128 v[44:47], v28 offset:96
s_waitcnt lgkmcnt(0)
v_cndmask_b32 v32, 1.0, v32, s[28:29]
v_cndmask_b32 v33, 1.0, v33, s[28:29]
v_cndmask_b32 v34, 1.0, v34, s[28:29]
v_cndmask_b32 v35, 1.0, v35, s[28:29]
v_cndmask_b32 v36, 1.0, v36, s[28:29]
v_cndmask_b32 v37, 1.0, v37, s[28:29]
v_cndmask_b32 v38, 1.0, v38, s[28:29]
v_cndmask_b32 v39, 1.0, v39, s[28:29]
v_cndmask_b32 v40, 1.0, v40, vcc
v_cndmask_b32 v41, 1.0, v41, vcc
v_cndmask_b32 v42, 1.0, v42, vcc
v_cndmask_b32 v43, 1.0, v43, vcc
v_cndmask_b32 v44, 1.0, v44, vcc
v_cndmask_b32 v45, 1.0, v45, vcc
v_cndmask_b32 v46, 1.0, v46, vcc
v_cndmask_b32 v47, 1.0, v47, vcc
v_mul_f32 v160, v160, v32
v_mul_f32 v161, v161, v33
v_mul_f32 v162, v162, v34
v_mul_f32 v163, v163, v35
v_mul_f32 v164, v164, v36
v_mul_f32 v165, v165, v37
v_mul_f32 v166, v166, v38
v_mul_f32 v167, v167, v39
v_mul_f32 v168, v168, v40
v_mul_f32 v169, v169, v41
v_mul_f32 v170, v170, v42
v_mul_f32 v171, v171, v43
v_mul_f32 v172, v172, v44
v_mul_f32 v173, v173, v45
v_mul_f32 v174, v174, v46
v_mul_f32 v175, v175, v47
v_mul_f32 v176, v176, v32
v_mul_f32 v177, v177, v33
v_mul_f32 v178, v178, v34
v_mul_f32 v179, v179, v35
v_mul_f32 v180, v180, v36
v_mul_f32 v181, v181, v37
v_mul_f32 v182, v182, v38
v_mul_f32 v183, v183, v39
v_mul_f32 v184, v184, v40
v_mul_f32 v185, v185, v41
v_mul_f32 v186, v186, v42
v_mul_f32 v187, v187, v43
v_mul_f32 v188, v188, v44
v_mul_f32 v189, v189, v45
v_mul_f32 v190, v190, v46
v_mul_f32 v191, v191, v47
v_mul_f32 v192, v192, v32
v_mul_f32 v193, v193, v33
v_mul_f32 v194, v194, v34
v_mul_f32 v195, v195, v35
v_mul_f32 v196, v196, v36
v_mul_f32 v197, v197, v37
v_mul_f32 v198, v198, v38
v_mul_f32 v199, v199, v39
v_mul_f32 v200, v200, v40
v_mul_f32 v201, v201, v41
v_mul_f32 v202, v202, v42
v_mul_f32 v203, v203, v43
v_mul_f32 v204, v204, v44
v_mul_f32 v205, v205, v45
v_mul_f32 v206, v206, v46
v_mul_f32 v207, v207, v47
v_mul_f32 v208, v208, v32
v_mul_f32 v209, v209, v33
v_mul_f32 v210, v210, v34
v_mul_f32 v211, v211, v35
v_mul_f32 v212, v212, v36
v_mul_f32 v213, v213, v37
v_mul_f32 v214, v214, v38
v_mul_f32 v215, v215, v39
v_mul_f32 v216, v216, v40
v_mul_f32 v217, v217, v41
v_mul_f32 v218, v218, v42
v_mul_f32 v219, v219, v43
v_mul_f32 v220, v220, v44
v_mul_f32 v221, v221, v45
v_mul_f32 v222, v222, v46
v_mul_f32 v223, v223, v47
v_mul_f32 v224, v224, v32
v_mul_f32 v225, v225, v33
v_mul_f32 v226, v226, v34
v_mul_f32 v227, v227, v35
v_mul_f32 v228, v228, v36
v_mul_f32 v229, v229, v37
v_mul_f32 v230, v230, v38
v_mul_f32 v231, v231, v39
v_mul_f32 v232, v232, v40
v_mul_f32 v233, v233, v41
v_mul_f32 v234, v234, v42
v_mul_f32 v235, v235, v43
v_mul_f32 v236, v236, v44
v_mul_f32 v237, v237, v45
v_mul_f32 v238, v238, v46
v_mul_f32 v239, v239, v47
v_mul_f32 v240, v240, v32
v_mul_f32 v241, v241, v33
v_mul_f32 v242, v242, v34
v_mul_f32 v243, v243, v35
v_mul_f32 v244, v244, v36
v_mul_f32 v245, v245, v37
v_mul_f32 v246, v246, v38
v_mul_f32 v247, v247, v39
v_mul_f32 v248, v248, v40
v_mul_f32 v249, v249, v41
v_mul_f32 v250, v250, v42
v_mul_f32 v251, v251, v43
v_mul_f32 v252, v252, v44
v_mul_f32 v253, v253, v45
v_mul_f32 v254, v254, v46
v_mul_f32 v255, v255, v47
s_nop 0
s_branch YH_go
Y_lo:
s_mov_b32 s26, 30720
s_mov_b32 s27, 4294844416
s_mov_b32 s16, 2704
s_mov_b32 s17, 4294961888
s_mov_b32 s30, 2097152
s_branch YL_top
.p2align 6
YL_top:
ds_read_b128 v[16:19], v21
ds_read_b64 v[8:9], v20
ds_read_b64_tr_b16 v[64:65], v4 offset:0
ds_read_b64_tr_b16 v[66:67], v5 offset:0
ds_read_b64_tr_b16 v[68:69], v4 offset:256
ds_read_b64_tr_b16 v[70:71], v5 offset:256
ds_read_b64_tr_b16 v[72:73], v4 offset:512
ds_read_b64_tr_b16 v[74:75], v5 offset:512
s_waitcnt lgkmcnt(7)
v_min_u32 v16, v16, v17
v_max_u32 v17, v18, v19
v_cmp_gt_u32 s[28:29], s23, v16
v_cmp_eq_u32 vcc, s23, v17
s_or_b64 vcc, vcc, s[28:29]
s_cbranch_scc1 YL_fix
YL_go:
s_waitcnt lgkmcnt(5)
v_mfma_f32_32x32x8_bf16 v[160:175], v[8:9], v[64:65], v[160:175]
ds_read2_b32 v[26:27], v22 offset0:1 offset1:17
ds_write_b32 v24, v23
s_add_u32 s20, s20, 1
s_cmp_eq_u32 s20, 5
s_cselect_b32 s24, s27, s26
s_waitcnt lgkmcnt(6)
v_mfma_f32_32x32x8_bf16 v[176:191], v[8:9], v[66:67], v[176:191]
s_cselect_b32 s20, 0, s20
s_add_u32 s19, s19, 1
s_cmp_eq_u32 s19, 3
s_waitcnt lgkmcnt(5)
v_mfma_f32_32x32x8_bf16 v[192:207], v[8:9], v[68:69], v[192:207]
s_cselect_b32 s18, s17, s16
s_cselect_b32 s19, 0, s19
s_add_u32 s23, s23, 1
s_waitcnt lgkmcnt(4)
v_mfma_f32_32x32x8_bf16 v[208:223], v[8:9], v[70:71], v[208:223]
s_mov_b32 s30, 2097152
v_add_u32 v4, s24, v4
v_add_u32 v5, s24, v5
s_waitcnt lgkmcnt(3)
v_mfma_f32_32x32x8_bf16 v[224:239], v[8:9], v[72:73], v[224:239]
v_add_u32 v20, s18, v20
v_add_u32 v21, s18, v21
v_add_u32 v23, 1, v23
s_waitcnt lgkmcnt(2)
v_mfma_f32_32x32x8_bf16 v[240:255], v[8:9], v[74:75], v[240:255]
s_waitcnt lgkmcnt(1)
v_cmp_gt_u32 vcc, s23, v26
s_cbranch_vccz YL_top
s_branch Y_exit
YL_fix:
s_cmp_lg_u64 s[28:29], 0
s_cbranch_scc0 YL_resc
YL_sp:
ds_read_b64 v[16:17], v21
ds_read_b32 v18, v22 offset:4
s_sub_u32 s30, s30, 1
s_cbranch_scc1 Y_exit
s_waitcnt lgkmcnt(0)
v_min_u32 v16, v16, v17
v_cmp_gt_u32 s[28:29], s23, v18
v_cmp_gt_u32 vcc, s23, v16
s_cmp_lg_u64 s[28:29], 0
s_cbranch_scc1 Y_exit
s_cbranch_vccz YL_top
s_branch YL_sp
YL_resc:
v_add_u32 v28, v21, v25
v_cmp_eq_u32 s[28:29], s23, v18
v_cmp_eq_u32 vcc, s23, v19
ds_read_b128 v[32:35], v28 offset:0
ds_read_b128 v[36:39], v28 offset:32
ds_read_b128 v[40:43], v28 offset:64
ds_read_b128 v[44:47], v28 offset:96
s_waitcnt lgkmcnt(0)
v_cndmask_b32 v32, 1.0, v32, s[28:29]
v_cndmask_b32 v33, 1.0, v33, s[28:29]
v_cndmask_b32 v34, 1.0, v34, s[28:29]
v_cndmask_b32 v35, 1.0, v35, s[28:29]
v_cndmask_b32 v36, 1.0, v36, s[28:29]
v_cndmask_b32 v37, 1.0, v37, s[28:29]
v_cndmask_b32 v38, 1.0, v38, s[28:29]
v_cndmask_b32 v39, 1.0, v39, s[28:29]
v_cndmask_b32 v40, 1.0, v40, vcc
v_cndmask_b32 v41, 1.0, v41, vcc
v_cndmask_b32 v42, 1.0, v42, vcc
v_cndmask_b32 v43, 1.0, v43, vcc
v_cndmask_b32 v44, 1.0, v44, vcc
v_cndmask_b32 v45, 1.0, v45, vcc
v_cndmask_b32 v46, 1.0, v46, vcc
v_cndmask_b32 v47, 1.0, v47, vcc
v_mul_f32 v160, v160, v32
v_mul_f32 v161, v161, v33
v_mul_f32 v162, v162, v34
v_mul_f32 v163, v163, v35
v_mul_f32 v164, v164, v36
v_mul_f32 v165, v165, v37
v_mul_f32 v166, v166, v38
v_mul_f32 v167, v167, v39
v_mul_f32 v168, v168, v40
v_mul_f32 v169, v169, v41
v_mul_f32 v170, v170, v42
v_mul_f32 v171, v171, v43
v_mul_f32 v172, v172, v44
v_mul_f32 v173, v173, v45
v_mul_f32 v174, v174, v46
v_mul_f32 v175, v175, v47
v_mul_f32 v176, v176, v32
v_mul_f32 v177, v177, v33
v_mul_f32 v178, v178, v34
v_mul_f32 v179, v179, v35
v_mul_f32 v180, v180, v36
v_mul_f32 v181, v181, v37
v_mul_f32 v182, v182, v38
v_mul_f32 v183, v183, v39
v_mul_f32 v184, v184, v40
v_mul_f32 v185, v185, v41
v_mul_f32 v186, v186, v42
v_mul_f32 v187, v187, v43
v_mul_f32 v188, v188, v44
v_mul_f32 v189, v189, v45
v_mul_f32 v190, v190, v46
v_mul_f32 v191, v191, v47
v_mul_f32 v192, v192, v32
v_mul_f32 v193, v193, v33
v_mul_f32 v194, v194, v34
v_mul_f32 v195, v195, v35
v_mul_f32 v196, v196, v36
v_mul_f32 v197, v197, v37
v_mul_f32 v198, v198, v38
v_mul_f32 v199, v199, v39
v_mul_f32 v200, v200, v40
v_mul_f32 v201, v201, v41
v_mul_f32 v202, v202, v42
v_mul_f32 v203, v203, v43
v_mul_f32 v204, v204, v44
v_mul_f32 v205, v205, v45
v_mul_f32 v206, v206, v46
v_mul_f32 v207, v207, v47
v_mul_f32 v208, v208, v32
v_mul_f32 v209, v209, v33
v_mul_f32 v210, v210, v34
v_mul_f32 v211, v211, v35
v_mul_f32 v212, v212, v36
v_mul_f32 v213, v213, v37
v_mul_f32 v214, v214, v38
v_mul_f32 v215, v215, v39
v_mul_f32 v216, v216, v40
v_mul_f32 v217, v217, v41
v_mul_f32 v218, v218, v42
v_mul_f32 v219, v219, v43
v_mul_f32 v220, v220, v44
v_mul_f32 v221, v221, v45
v_mul_f32 v222, v222, v46
v_mul_f32 v223, v223, v47
v_mul_f32 v224, v224, v32
v_mul_f32 v225, v225, v33
v_mul_f32 v226, v226, v34
v_mul_f32 v227, v227, v35
v_mul_f32 v228, v228, v36
v_mul_f32 v229, v229, v37
v_mul_f32 v230, v230, v38
v_mul_f32 v231, v231, v39
v_mul_f32 v232, v232, v40
v_mul_f32 v233, v233, v41
v_mul_f32 v234, v234, v42
v_mul_f32 v235, v235, v43
v_mul_f32 v236, v236, v44
v_mul_f32 v237, v237, v45
v_mul_f32 v238, v238, v46
v_mul_f32 v239, v239, v47
v_mul_f32 v240, v240, v32
v_mul_f32 v241, v241, v33
v_mul_f32 v242, v242, v34
v_mul_f32 v243, v243, v35
v_mul_f32 v244, v244, v36
v_mul_f32 v245, v245, v37
v_mul_f32 v246, v246, v38
v_mul_f32 v247, v247, v39
v_mul_f32 v248, v248, v40
v_mul_f32 v249, v249, v41
v_mul_f32 v250, v250, v42
v_mul_f32 v251, v251, v43
v_mul_f32 v252, v252, v44
v_mul_f32 v253, v253, v45
v_mul_f32 v254, v254, v46
v_mul_f32 v255, v255, v47
s_nop 0
s_branch YL_go
Y_exit:
v_cmp_ne_u32 vcc, 2, v27
s_cbranch_vccnz Y_other
Y_local:
s_add_u32 s42, s40, 393216
s_add_u32 s43, s40, 786432
s_add_u32 s46, s40, 1179648
v_cvt_pk_bf16_f32 v64, v160, v176
v_cvt_pk_bf16_f32 v65, v161, v177
v_cvt_pk_bf16_f32 v66, v162, v178
v_cvt_pk_bf16_f32 v67, v163, v179
buffer_store_dwordx4 v[64:67], v2, s[32:35], s40 offen offset:0
v_cvt_pk_bf16_f32 v68, v164, v180
v_cvt_pk_bf16_f32 v69, v165, v181
v_cvt_pk_bf16_f32 v70, v166, v182
v_cvt_pk_bf16_f32 v71, v167, v183
buffer_store_dwordx4 v[68:71], v2, s[32:35], s42 offen offset:0
v_cvt_pk_bf16_f32 v72, v168, v184
v_cvt_pk_bf16_f32 v73, v169, v185
v_cvt_pk_bf16_f32 v74, v170, v186
v_cvt_pk_bf16_f32 v75, v171, v187
buffer_store_dwordx4 v[72:75], v2, s[32:35], s43 offen offset:0
v_cvt_pk_bf16_f32 v76, v172, v188
v_cvt_pk_bf16_f32 v77, v173, v189
v_cvt_pk_bf16_f32 v78, v174, v190
v_cvt_pk_bf16_f32 v79, v175, v191
buffer_store_dwordx4 v[76:79], v2, s[32:35], s46 offen offset:0
v_cvt_pk_bf16_f32 v80, v192, v208
v_cvt_pk_bf16_f32 v81, v193, v209
v_cvt_pk_bf16_f32 v82, v194, v210
v_cvt_pk_bf16_f32 v83, v195, v211
buffer_store_dwordx4 v[80:83], v2, s[32:35], s40 offen offset:512
v_cvt_pk_bf16_f32 v84, v196, v212
v_cvt_pk_bf16_f32 v85, v197, v213
v_cvt_pk_bf16_f32 v86, v198, v214
v_cvt_pk_bf16_f32 v87, v199, v215
buffer_store_dwordx4 v[84:87], v2, s[32:35], s42 offen offset:512
v_cvt_pk_bf16_f32 v88, v200, v216
v_cvt_pk_bf16_f32 v89, v201, v217
v_cvt_pk_bf16_f32 v90, v202, v218
v_cvt_pk_bf16_f32 v91, v203, v219
buffer_store_dwordx4 v[88:91], v2, s[32:35], s43 offen offset:512
v_cvt_pk_bf16_f32 v92, v204, v220
v_cvt_pk_bf16_f32 v93, v205, v221
v_cvt_pk_bf16_f32 v94, v206, v222
v_cvt_pk_bf16_f32 v95, v207, v223
buffer_store_dwordx4 v[92:95], v2, s[32:35], s46 offen offset:512
v_cvt_pk_bf16_f32 v96, v224, v240
v_cvt_pk_bf16_f32 v97, v225, v241
v_cvt_pk_bf16_f32 v98, v226, v242
v_cvt_pk_bf16_f32 v99, v227, v243
buffer_store_dwordx4 v[96:99], v2, s[32:35], s40 offen offset:1024
v_cvt_pk_bf16_f32 v100, v228, v244
v_cvt_pk_bf16_f32 v101, v229, v245
v_cvt_pk_bf16_f32 v102, v230, v246
v_cvt_pk_bf16_f32 v103, v231, v247
buffer_store_dwordx4 v[100:103], v2, s[32:35], s42 offen offset:1024
v_cvt_pk_bf16_f32 v104, v232, v248
v_cvt_pk_bf16_f32 v105, v233, v249
v_cvt_pk_bf16_f32 v106, v234, v250
v_cvt_pk_bf16_f32 v107, v235, v251
buffer_store_dwordx4 v[104:107], v2, s[32:35], s43 offen offset:1024
v_cvt_pk_bf16_f32 v108, v236, v252
v_cvt_pk_bf16_f32 v109, v237, v253
v_cvt_pk_bf16_f32 v110, v238, v254
v_cvt_pk_bf16_f32 v111, v239, v255
buffer_store_dwordx4 v[108:111], v2, s[32:35], s46 offen offset:1024
s_mov_b64 exec, 1
s_waitcnt vmcnt(0)
buffer_store_dword v3, off, s[32:35], s41
s_endpgm
Y_other:
s_mov_b32 s30, 2097152
W49:
ds_read_b32 v26, v22 offset:68
s_sub_u32 s30, s30, 1
s_cselect_b32 s25, 0, 1
s_waitcnt lgkmcnt(0)
v_cmp_gt_u32 vcc, s25, v26
s_cbranch_vccnz W49
v_cmp_eq_u32 vcc, 2, v26
s_cbranch_vccnz Y_local
s_add_u32 s42, s40, 393216
s_add_u32 s43, s40, 786432
s_add_u32 s46, s40, 1179648
v_cvt_pk_bf16_f32 v64, v160, v176
v_cvt_pk_bf16_f32 v65, v161, v177
v_cvt_pk_bf16_f32 v66, v162, v178
v_cvt_pk_bf16_f32 v67, v163, v179
buffer_store_dwordx4 v[64:67], v2, s[32:35], s40 offen offset:0 sc1
v_cvt_pk_bf16_f32 v68, v164, v180
v_cvt_pk_bf16_f32 v69, v165, v181
v_cvt_pk_bf16_f32 v70, v166, v182
v_cvt_pk_bf16_f32 v71, v167, v183
buffer_store_dwordx4 v[68:71], v2, s[32:35], s42 offen offset:0 sc1
v_cvt_pk_bf16_f32 v72, v168, v184
v_cvt_pk_bf16_f32 v73, v169, v185
v_cvt_pk_bf16_f32 v74, v170, v186
v_cvt_pk_bf16_f32 v75, v171, v187
buffer_store_dwordx4 v[72:75], v2, s[32:35], s43 offen offset:0 sc1
v_cvt_pk_bf16_f32 v76, v172, v188
v_cvt_pk_bf16_f32 v77, v173, v189
v_cvt_pk_bf16_f32 v78, v174, v190
v_cvt_pk_bf16_f32 v79, v175, v191
buffer_store_dwordx4 v[76:79], v2, s[32:35], s46 offen offset:0 sc1
v_cvt_pk_bf16_f32 v80, v192, v208
v_cvt_pk_bf16_f32 v81, v193, v209
v_cvt_pk_bf16_f32 v82, v194, v210
v_cvt_pk_bf16_f32 v83, v195, v211
buffer_store_dwordx4 v[80:83], v2, s[32:35], s40 offen offset:512 sc1
v_cvt_pk_bf16_f32 v84, v196, v212
v_cvt_pk_bf16_f32 v85, v197, v213
v_cvt_pk_bf16_f32 v86, v198, v214
v_cvt_pk_bf16_f32 v87, v199, v215
buffer_store_dwordx4 v[84:87], v2, s[32:35], s42 offen offset:512 sc1
v_cvt_pk_bf16_f32 v88, v200, v216
v_cvt_pk_bf16_f32 v89, v201, v217
v_cvt_pk_bf16_f32 v90, v202, v218
v_cvt_pk_bf16_f32 v91, v203, v219
buffer_store_dwordx4 v[88:91], v2, s[32:35], s43 offen offset:512 sc1
v_cvt_pk_bf16_f32 v92, v204, v220
v_cvt_pk_bf16_f32 v93, v205, v221
v_cvt_pk_bf16_f32 v94, v206, v222
v_cvt_pk_bf16_f32 v95, v207, v223
buffer_store_dwordx4 v[92:95], v2, s[32:35], s46 offen offset:512 sc1
v_cvt_pk_bf16_f32 v96, v224, v240
v_cvt_pk_bf16_f32 v97, v225, v241
v_cvt_pk_bf16_f32 v98, v226, v242
v_cvt_pk_bf16_f32 v99, v227, v243
buffer_store_dwordx4 v[96:99], v2, s[32:35], s40 offen offset:1024 sc1
v_cvt_pk_bf16_f32 v100, v228, v244
v_cvt_pk_bf16_f32 v101, v229, v245
v_cvt_pk_bf16_f32 v102, v230, v246
v_cvt_pk_bf16_f32 v103, v231, v247
buffer_store_dwordx4 v[100:103], v2, s[32:35], s42 offen offset:1024 sc1
v_cvt_pk_bf16_f32 v104, v232, v248
v_cvt_pk_bf16_f32 v105, v233, v249
v_cvt_pk_bf16_f32 v106, v234, v250
v_cvt_pk_bf16_f32 v107, v235, v251
buffer_store_dwordx4 v[104:107], v2, s[32:35], s43 offen offset:1024 sc1
v_cvt_pk_bf16_f32 v108, v236, v252
v_cvt_pk_bf16_f32 v109, v237, v253
v_cvt_pk_bf16_f32 v110, v238, v254
v_cvt_pk_bf16_f32 v111, v239, v255
buffer_store_dwordx4 v[108:111], v2, s[32:35], s46 offen offset:1024 sc1
s_mov_b64 exec, 1
s_waitcnt vmcnt(0)
buffer_store_dword v3, off, s[32:35], s41 sc1
s_endpgm
K_done:
s_endpgm
.section .rodata,"a"
.p2align 6
.amdhsa_kernel standalone__detection_seg_detr_decoder__vision_kernel
  .amdhsa_next_free_vgpr 256
  .amdhsa_next_free_sgpr 102
  .amdhsa_accum_offset 256
  .amdhsa_group_segment_fixed_size 0
  .amdhsa_kernarg_size 104
  .amdhsa_user_sgpr_count 2
  .amdhsa_user_sgpr_kernarg_segment_ptr 1
  .amdhsa_system_sgpr_workgroup_id_x 1
.end_amdhsa_kernel
```
